```python
import torch

def _softmax(x, axis=-1):
    return torch.softmax(x, dim=axis)
def _gelu(x):
    return torch.nn.functional.gelu(x, approximate="tanh")
def _silu(x):
    return torch.nn.functional.silu(x)
def _sigmoid(x):
    return torch.sigmoid(x)
def _layernorm(x, axis=-1, eps=1e-5):
    m = x.mean(dim=axis, keepdim=True)
    v = x.var(dim=axis, keepdim=True, unbiased=False)
    return (x - m) / torch.sqrt(v + eps)
def _scatter_add(tgt, idx, src, axis=0):
    return tgt.clone().index_add_(axis, idx, src)
def _segment_sum(src, seg, n):
    out = torch.zeros((n,) + src.shape[1:], dtype=src.dtype)
    return out.index_add_(0, seg, src)
def _pad(x, pw):
    flat = tuple(v for pair in reversed(pw) for v in pair)
    return torch.nn.functional.pad(x, flat)

kernel_name = 'sequential_preLN__linear_attn_block__dense_activation_squared_relu__prompt'

def setup_inputs():

    _w = (lambda a: (lambda t: t.to(torch.bfloat16) if t.is_floating_point() else t)(torch.as_tensor(a)))
    def _A_setup():
        B, S, D = 1, 2048, 448
        return {
            "x": _w((lambda *s: torch.randn(*s, dtype=torch.bfloat16) * 0.05)(B, S, D)),
            "wqkv": _w((lambda *s: torch.randn(*s, dtype=torch.bfloat16) * 0.1)(D, 3 * D)),
            "wo": _w((lambda *s: torch.randn(*s, dtype=torch.bfloat16) * 0.05)(D, D)),
        }
    _A_in = _A_setup()

    def _B_setup():
        B, S, D, F = 1, 2048, 448, 1792
        return {
            "x": _w((lambda *s: torch.randn(*s, dtype=torch.bfloat16) * 0.05)(B, S, D)),
            "w1": _w((lambda *s: torch.randn(*s, dtype=torch.bfloat16) * 0.05)(D, F)),
            "b1": _w((lambda *s: torch.randn(*s, dtype=torch.bfloat16) * 0.2)(F)),
            "w2": _w((lambda *s: torch.randn(*s, dtype=torch.bfloat16) * 0.05)(F, D)),
            "b2": _w((lambda *s: torch.randn(*s, dtype=torch.bfloat16) * 0.8)(D)),
        }
    _B_in = _B_setup()

    return {
        "A_x": _A_in["x"],
        "A_wqkv": _A_in["wqkv"],
        "A_wo": _A_in["wo"],
        "B_x": _B_in["x"],
        "B_w1": _B_in["w1"],
        "B_b1": _B_in["b1"],
        "B_w2": _B_in["w2"],
        "B_b2": _B_in["b2"],
    }

def reference(A_x, A_wqkv, A_wo, B_x, B_w1, B_b1, B_w2, B_b2):
    def _A_ref(x, wqkv, wo):
        B, S, D = x.shape
        H = 16; Dh = D // H
        qkv = (lambda x, *d: x.permute(*d))((x @ wqkv).reshape(B, S, 3, H, Dh), 2, 0, 3, 1, 4)
        q, k, v = qkv[0], qkv[1], qkv[2]
        phi = lambda t: torch.where(t > 0, t + 1, torch.exp(t)) + 1e-6
        pq, pk = phi(q), phi(k)
        kv = torch.einsum("bhsd,bhse->bhde", pk, v)
        z = torch.einsum("bhsd->bhd", pk)
        num = torch.einsum("bhqd,bhde->bhqe", pq, kv)
        den = torch.einsum("bhqd,bhd->bhq", pq, z)[..., None] + 1e-6
        o = num / den
        return (lambda x, *d: x.permute(*d))(o, 0, 2, 1, 3).reshape(B, S, D) @ wo

    def _B_ref(x, w1, b1, w2, b2):
        h = torch.einsum("bsd,df->bsf", x, w1) + b1
        zero = torch.zeros_like(h)
        r = torch.where(h > zero, h, zero)
        h = r * r
        out = torch.einsum("bsf,fd->bsd", h, w2) + b2
        return out

    x = A_x
    h = x + _A_ref(_layernorm(x, axis=-1), A_wqkv, A_wo)
    h2 = h + _B_ref(_layernorm(h, axis=-1), B_w1, B_b1, B_w2, B_b2)
    return h2
```

```asm
; @launch grid=(256,1,1) block=(256,1,1) lds=163840
.amdgcn_target "amdgcn-amd-amdhsa--gfx950"
.text
.globl sequential_preLN__linear_attn_block__dense_activation_squared_relu__prompt_kernel
.p2align 8
.type sequential_preLN__linear_attn_block__dense_activation_squared_relu__prompt_kernel,@function
sequential_preLN__linear_attn_block__dense_activation_squared_relu__prompt_kernel:
    s_cmp_ge_u32 s2, 256
    s_cbranch_scc1 Lend
    s_load_dwordx16 s[44:59], s[0:1], 0
    s_load_dwordx2 s[32:33], s[0:1], 64
    s_load_dwordx2 s[28:29], s[0:1], 80
    v_lshrrev_b32 v2, 6, v0
    v_and_b32 v1, 63, v0
    s_and_b32 s62, s2, 7
    s_lshr_b32 s63, s2, 3
    v_readfirstlane_b32 s3, v2
    s_lshr_b32 s64, s63, 4
    s_lshl_b32 s4, s62, 1
    s_add_u32 s4, s4, s64
    s_and_b32 s30, s63, 15
    s_and_b32 s31, s64, 0
    s_xor_b32 s5, s30, s31
    s_mul_i32 s64, s64, 3
    s_add_u32 s6, s5, s64
    s_add_u32 s6, s6, s62
    s_mul_i32 s64, s6, 37
    s_lshr_b32 s64, s64, 8
    s_mul_i32 s64, s64, 7
    s_sub_u32 s6, s6, s64
    v_lshrrev_b32 v10, 3, v1
    v_and_b32 v11, 7, v1
    v_lshrrev_b32 v12, 1, v10
    v_xor_b32_e64 v13, v11, v12
    v_mul_u32_u24 v14, 896, v10
    v_lshl_add_u32 v2, v13, 4, v14
    v_xor_b32_e64 v13, 4, v13
    v_lshl_add_u32 v3, v13, 4, v14
    v_add_u32 v3, 6144, v3
    v_add_u32 v4, 12288, v2
    v_add_u32 v5, 12288, v3
    v_lshrrev_b32_e64 v10, 2, v1
    v_and_b32 v11, 3, v1
    v_mul_u32_u24 v10, 2688, v10
    v_lshl_add_u32 v227, v11, 4, v10
    v_add_u32 v6, 128, v227
    s_lshl_b32 s65, s4, 2
    s_add_u32 s65, s65, s3
    s_mul_i32 s65, s65, 28672
    s_lshl_b32 s62, s6, 7
    s_add_u32 s65, s65, s62
    s_mul_i32 s66, s30, 56
    s_and_b32 s66, s66, 0xfffffff0
    s_add_u32 s66, s66, 768
    s_mul_i32 s62, s3, 43008
    s_add_u32 s66, s66, s62
    s_mul_i32 s62, s6, 172032
    s_add_u32 s66, s66, s62
    s_lshl_b32 s68, s3, 12
    s_lshl_b32 s69, s3, 11
    s_mov_b32 s10, 1835008
    s_mov_b32 s11, 0x20000
    s_mov_b32 s14, 1204224
    s_mov_b32 s15, 0x20000
    s_waitcnt lgkmcnt(0)
    s_mov_b32 s12, s46
    s_and_b32 s13, s47, 0xffff
    s_mov_b32 s8, s44
    s_and_b32 s9, s45, 0xffff
    s_add_u32 m0, s69, 16384
    s_nop 0
    buffer_load_dwordx4 v6, s[12:15], s66 offen lds
    buffer_load_dwordx4 v227, s[12:15], s66 offen offset:1024 lds
    s_add_u32 m0, s68, 0
    s_add_u32 s66, s66, 172032
    buffer_load_dwordx4 v2, s[8:11], s65 offen offset:0 lds
    buffer_load_dwordx4 v3, s[8:11], s65 offen offset:1024 lds
    buffer_load_dwordx4 v4, s[8:11], s65 offen offset:2048 lds
    buffer_load_dwordx4 v5, s[8:11], s65 offen offset:3072 lds
    s_add_u32 s65, s65, 128
    s_cmp_eq_u32 s6, 6
    s_cselect_b32 s62, 896, 0
    s_cselect_b32 s63, 1204224, 0
    s_sub_u32 s65, s65, s62
    s_sub_u32 s66, s66, s63
    s_load_dword s60, s[28:29], 0
    s_getpc_b64 s[34:35]
Lpc0:
    s_sub_u32 s34, s34, Lpc0-sequential_preLN__linear_attn_block__dense_activation_squared_relu__prompt_kernel
    s_subb_u32 s35, s35, 0
    s_lshl_b32 s64, s3, 9
    s_add_u32 s36, s34, s64
    s_addc_u32 s37, s35, 0
    s_load_dword s50, s[36:37], 640
    s_load_dword s51, s[36:37], 704
    s_load_dword s50, s[36:37], 768
    s_load_dword s51, s[36:37], 832
    s_load_dword s50, s[36:37], 896
    s_load_dword s51, s[36:37], 960
    s_load_dword s50, s[36:37], 1024
    s_load_dword s51, s[36:37], 1088
    s_lshr_b32 s64, s2, 3
    s_lshl_b32 s64, s64, 2
    s_add_u32 s64, s64, s3
    s_lshl_b32 s64, s64, 8
    s_min_u32 s64, s64, Lend-sequential_preLN__linear_attn_block__dense_activation_squared_relu__prompt_kernel-192
    s_add_u32 s34, s34, s64
    s_addc_u32 s35, s35, 0
    s_load_dword s50, s[34:35], 0
    s_load_dword s51, s[34:35], 64
    s_load_dword s50, s[34:35], 128
    s_load_dword s51, s[34:35], 192
    s_add_u32 m0, s69, 40960
    s_nop 0
    buffer_load_dwordx4 v6, s[12:15], s66 offen lds
    buffer_load_dwordx4 v227, s[12:15], s66 offen offset:1024 lds
    s_mov_b32 s16, s48
    s_and_b32 s17, s49, 0xffff
    s_mov_b32 s18, 401408
    s_mov_b32 s19, 0x20000
    s_mov_b32 s20, s52
    s_and_b32 s21, s53, 0xffff
    s_mov_b32 s22, 1605632
    s_mov_b32 s23, 0x20000
    s_mov_b32 s36, s54
    s_and_b32 s37, s55, 0xffff
    s_mov_b32 s38, 3584
    s_mov_b32 s39, 0x20000
    s_mov_b32 s24, s56
    s_and_b32 s25, s57, 0xffff
    s_mov_b32 s26, 1605632
    s_mov_b32 s27, 0x20000
    s_mov_b32 s40, s58
    s_and_b32 s41, s59, 0xffff
    s_mov_b32 s42, 896
    s_mov_b32 s43, 0x20000
    s_and_b32 s33, s33, 0xffff
    s_mov_b32 s34, 1835008
    s_mov_b32 s35, 0x20000
    s_and_b32 s29, s29, 0xffff
    s_mov_b32 s30, 17825792
    s_mov_b32 s31, 0x20000
    s_cmp_ge_u32 s5, 7
    s_cselect_b32 s7, 1, 0
    s_mov_b32 s61, 0x3f803f80
    v_mov_b32 v15, 0
    v_and_b32 v10, 31, v1
    v_lshrrev_b32_e64 v11, 5, v1
    v_bfe_u32 v13, v1, 1, 3
    v_xor_b32 v12, v13, v11
    v_lshlrev_b32 v12, 4, v12
    v_lshl_add_u32 v192, v10, 7, v12
    v_add_u32 v192, s68, v192
    s_lshl_b32 s59, s3, 5
    v_xor_b32 v192, s59, v192
    v_xor_b32 v193, 32, v192
    v_xor_b32_e64 v194, 64, v192
    v_xor_b32 v195, 0x60, v192
    s_lshr_b32 s64, s3, 1
    s_lshl_b32 s64, s64, 1
    s_add_u32 s64, s64, s7
    s_lshl_b32 s64, s64, 12
    s_and_b32 s59, s3, 1
    s_lshl_b32 s59, s59, 2
    v_xor_b32 v12, s59, v13
    v_lshlrev_b32 v12, 4, v12
    v_lshl_add_u32 v12, v10, 7, v12
    v_lshl_add_u32 v12, v11, 3, v12
    v_add_u32 v12, s64, v12
    v_xor_b32 v7, 16, v12
    v_xor_b32 v8, 32, v12
    v_xor_b32 v9, 48, v12
    v_bfe_u32 v13, v1, 4, 1
    v_and_b32_e64 v14, 3, v1
    v_lshl_add_u32 v14, v13, 2, v14
    s_bfe_u32 s64, s2, 0x10003
    v_add_u32 v14, s64, v14
    v_and_b32 v14, 7, v14
    v_lshlrev_b32_e64 v14, 3, v14
    v_bfe_u32 v13, v1, 2, 2
    v_lshl_add_u32 v13, v11, 3, v13
    v_lshl_add_u32 v226, v13, 6, v14
    s_add_u32 s59, s69, 16384
    v_add_u32_e64 v196, s59, v226
    v_xor_b32 v197, 0x800, v196
    v_xor_b32 v198, 0x1000, v196
    v_xor_b32 v199, 0x1800, v196
    v_lshrrev_b32 v13, 4, v1
    v_xor_b32 v13, v13, v1
    v_and_b32 v13, 1, v13
    v_cmp_eq_u32 vcc, 0, v13
    v_mov_b32 v13, s61
    v_mov_b32 v216, 0
    v_mov_b32 v217, 0
    v_cndmask_b32 v228, 0, v13, vcc
    v_mov_b32 v218, 0
    v_mov_b32 v219, 0
    v_mov_b32 v229, v228
    v_mov_b32 v230, v228
    v_mov_b32_e64 v231, v228
    v_add_u32 v200, 49152, v192
    v_add_u32 v201, 49152, v193
    v_add_u32 v202, 49152, v194
    v_add_u32 v203, 49152, v195
    v_add_u32 v204, 49152, v196
    v_add_u32 v205, 49152, v197
    v_add_u32 v206, 49152, v198
    v_add_u32 v207, 49152, v199
    s_lshl_b32 s52, s3, 10
    s_lshl_b32 s53, s5, 8
    s_mul_i32 s64, s3, 14336
    s_add_u32 s53, s53, s64
    s_and_b32 s64, s4, 1
    s_lshl_b32 s55, s64, 1
    s_and_b32 s59, s2, 1
    s_add_u32 s55, s55, s59
    s_mul_i32 s67, s64, 10
    s_lshl_b32 s64, s64, 1
    s_add_u32 s64, s64, s7
    s_mul_i32 s57, s3, 28672
    s_lshl_b32 s64, s6, 7
    s_add_u32 s57, s57, s64
    s_mul_i32 s64, s7, 114688
    s_sub_u32 s56, s57, s64
    s_add_u32 s56, s56, 114688
    s_add_u32 s57, s57, s64
    s_mov_b32 s48, 0x4f3f2f10
    s_mov_b32 s49, 0x98f7f6f5
    s_bfe_u32 s64, s2, 0x40003
    s_lshl_b32 s64, s64, 2
    s_lshr_b64 s[48:49], s[48:49], s64
    s_and_b32 s48, s48, 15
    s_add_u32 s67, s67, s48
    s_lshl_b32 s67, s67, 2
    s_add_u32 s67, s67, s3
    s_and_b32 s64, s2, 7
    s_mul_i32 s64, s64, 80
    s_add_u32 s67, s67, s64
    s_cmp_eq_u32 s48, 15
    s_cselect_b32 s67, 0x4000, s67
    s_mov_b32 s44, 0x358637bd
    s_mov_b32 s45, 0x358637bd
    s_mov_b32 s46, 0x3fb8aa3b
    s_mov_b32 s47, 0x3fb8aa3b
    v_lshrrev_b32 v128, 3, v1
    v_and_b32_e64 v129, 7, v1
    v_bfe_u32 v130, v1, 4, 1
    v_lshlrev_b32 v131, 2, v130
    v_xor_b32 v129, v129, v131
    v_mul_u32_u24 v128, 896, v128
    v_lshl_add_u32 v128, v129, 4, v128
    v_lshrrev_b32 v131, 4, v1
    v_and_b32 v129, 15, v1
    v_lshlrev_b32 v132, 2, v131
    v_xor_b32 v129, v129, v132
    v_mul_u32_u24 v131, 3584, v131
    v_lshl_add_u32 v129, v129, 4, v131
    v_lshlrev_b32_e64 v135, 7, v10
    v_bfe_u32 v133, v1, 2, 2
    v_lshl_add_u32 v134, v11, 2, v133
    v_lshlrev_b32 v131, 5, v130
    v_and_b32 v132, 3, v1
    v_lshl_add_u32 v131, v132, 3, v131
    v_xor_b32_e64 v132, s3, v133
    v_lshl_add_u32 v130, v132, 6, v131
    v_lshl_add_u32 v130, v134, 8, v130
    v_add_u32 v236, 98304, v130
    v_add_u32 v130, 65536, v130
    v_lshrrev_b32_e64 v132, 1, v133
    v_lshl_add_u32 v131, v132, 6, v131
    v_lshl_add_u32 v131, v134, 7, v131
    s_and_b32 s64, s3, 1
    s_lshl_b32 s64, s64, 6
    v_xor_b32_e64 v134, s64, v131
    s_add_u32 s64, s52, 98304
    v_add_u32 v131, s64, v131
    v_xor_b32 v132, 64, v131
    v_lshlrev_b32_e64 v133, 4, v10
    v_lshl_add_u32 v133, v11, 11, v133
    v_mov_b32_e64 v254, v129
    v_accvgpr_write_b32 a224, v128
    v_accvgpr_write_b32 a225, v129
    v_accvgpr_write_b32 a226, v130
    v_accvgpr_write_b32 a227, v131
    v_accvgpr_write_b32 a228, v132
    v_accvgpr_write_b32 a229, v133
    v_accvgpr_write_b32 a230, v134
    v_accvgpr_write_b32 a231, v135
    s_lshl_b32 s62, s5, 8
    s_lshl_b32 s63, s3, 6
    s_add_u32 s62, s62, s63
    v_lshlrev_b32 v13, 1, v10
    buffer_load_ushort a239, v13, s[36:39], s62 offen
    s_lshl_b32 s62, s6, 7
    v_and_b32 v13, 7, v1
    v_lshlrev_b32_e64 v13, 4, v13
    buffer_load_dwordx4 a[248:251], v13, s[40:43], s62 offen
    s_and_b32 s62, s3, 1
    s_lshl_b32 s62, s62, 1
    s_add_u32 s62, s62, s7
    s_lshl_b32 s63, s4, 2
    s_add_u32 s62, s62, s63
    s_lshl_b32 s62, s62, 1
    s_lshr_b32 s64, s3, 1
    s_add_u32 s62, s62, s64
    s_lshl_b32 s70, s62, 5
    s_add_u32 s70, s70, 4096
    s_mul_i32 s71, s62, 14336
    s_add_u32 s71, s71, 2097152
    s_and_b32 s72, s3, 1
    s_lshl_b32 s72, s72, 15
    s_lshl_b32 s62, s64, 14
    s_add_u32 s72, s72, s62
    s_lshl_b32 s64, s64, 1
    s_add_u32 s64, s64, s7
    s_add_u32 s64, s64, s63
    s_lshl_b32 s62, s6, 1
    s_and_b32 s59, s3, 1
    s_add_u32 s62, s62, s59
    s_mul_i32 s73, s64, 14
    s_add_u32 s73, s73, s62
    s_lshl_b32 s74, s73, 8
    s_add_u32 s74, s74, 6291456
    s_lshl_b32 s73, s73, 11
    s_add_u32 s73, s73, 4194304
    s_lshl_b32 s75, s64, 4
    s_add_u32 s75, s75, s62
    s_lshl_b32 s75, s75, 2
    s_add_u32 s75, s75, 8192
    s_lshl_b32 s76, s4, 8
    s_add_u32 s76, s76, 8192
    s_add_u32 s77, s63, s3
    s_mul_i32 s77, s77, 3584
    s_add_u32 s77, s77, 6291456
    s_add_u32 s62, s63, s3
    s_lshl_b32 s62, s62, 4
    s_bfe_u32 s59, s2, 0x40003
    s_xor_b32 s64, s59, 0
    s_add_u32 s62, s62, s64
    s_mul_i32 s78, s62, 1792
    s_add_u32 s78, s78, 2097152
    s_lshl_b32 s79, s62, 2
    s_add_u32 s79, s79, 4096
    s_lshl_b32 s62, s3, 9
    s_add_u32 s62, s62, 262144
    s_lshl_b32 s81, s64, 15
    s_add_u32 s81, s81, s62
    s_lshl_b32 s80, s59, 15
    s_add_u32 s80, s80, s62
    s_lshl_b32 s62, s4, 11
    s_add_u32 s80, s80, s62
    v_lshlrev_b32_e64 v13, 7, v1
    v_mov_b32 v248, 0x7ffffff0
    v_mov_b32 v249, 0x7ffffff0
    v_mov_b32 v250, 0x7ffffff0
    s_lshl_b32 s62, s2, 2
    s_add_u32 s62, s62, s3
    s_mov_b32 s62, s67
    s_mul_i32 s63, s62, 640
    s_mul_i32 s62, s62, 2560
    s_mov_b64 exec, 31
    v_add_u32_e64 v249, s63, v13
    s_mov_b64 exec, 1048575
    v_add_u32 v250, s62, v13
    s_lshl_b32 s62, s4, 8
    s_add_u32 s62, s62, 4096
    s_mul_i32 s63, s4, 768
    s_add_u32 s63, s63, 3840
    s_cmp_ge_u32 s5, 14
    s_cselect_b32 s64, 0, 0x4000
    s_lshl_b32 s64, s64, 12
    s_add_u32 s62, s62, s64
    s_mov_b64 exec, 0xfff
    v_add_u32 v248, s62, v13
    s_mov_b64 exec, 0xffc
    v_add_u32 v248, 3840, v248
    s_mov_b64 exec, 0xff0
    v_add_u32_e64 v248, s63, v248
    s_mov_b64 exec, -1
    s_and_b32 s62, s4, 1
    s_xor_b32 s62, s62, s7
    s_mul_i32 s63, s62, 28672
    s_add_u32 s43, s52, s63
    s_sub_u32 s58, s52, s63
    s_add_u32 m0, s68, 24576
    s_add_u32 s66, s66, 172032
    buffer_load_dwordx4 v2, s[8:11], s65 offen offset:0 lds
    buffer_load_dwordx4 v3, s[8:11], s65 offen offset:1024 lds
    buffer_load_dwordx4 v4, s[8:11], s65 offen offset:2048 lds
    buffer_load_dwordx4 v5, s[8:11], s65 offen offset:3072 lds
    s_add_u32 s65, s65, 128
    s_cmp_eq_u32 s6, 5
    s_cselect_b32 s62, 896, 0
    s_cselect_b32 s63, 1204224, 0
    s_sub_u32 s65, s65, s62
    s_sub_u32 s66, s66, s63
    s_waitcnt vmcnt(8) lgkmcnt(0)
    s_barrier
    ds_read_b64 a[240:241], v12
    ds_read_b64 a[242:243], v7
    ds_read_b64 a[244:245], v8
    ds_read_b64 a[246:247], v9
    ds_read_b128 v[16:19], v192 offset:0
    ds_read_b64_tr_b16 v[160:161], v196 offset:0
    ds_read_b64_tr_b16 v[162:163], v196 offset:256
    ds_read_b64_tr_b16 v[164:165], v196 offset:1024
    ds_read_b64_tr_b16 v[166:167], v196 offset:1280
    ds_read_b128 v[20:23], v193 offset:0
    ds_read_b64_tr_b16 v[168:169], v197 offset:0
    ds_read_b64_tr_b16 v[170:171], v197 offset:256
    ds_read_b64_tr_b16 v[172:173], v197 offset:1024
    ds_read_b64_tr_b16 v[174:175], v197 offset:1280
    ds_read_b128 v[24:27], v194 offset:0
    ds_read_b64_tr_b16 v[176:177], v198 offset:0
    ds_read_b64_tr_b16 v[178:179], v198 offset:256
    ds_read_b64_tr_b16 v[180:181], v198 offset:1024
    ds_read_b64_tr_b16 v[182:183], v198 offset:1280
    s_waitcnt lgkmcnt(12)
    v_mfma_f32_32x32x16_bf16 v[128:143], v[16:19], v[160:163], 0
    ds_read_b128 v[28:31], v195 offset:0
    ds_read_b64_tr_b16 v[184:185], v199 offset:0
    ds_read_b64_tr_b16 v[186:187], v199 offset:256
    ds_read_b64_tr_b16 v[188:189], v199 offset:1024
    ds_read_b64_tr_b16 v[190:191], v199 offset:1280
    s_waitcnt lgkmcnt(14)
    v_mfma_f32_32x32x16_bf16 v[144:159], v[16:19], v[164:167], 0
    s_add_u32 m0, s69, 65536
    s_nop 0
    buffer_load_dwordx4 v6, s[12:15], s66 offen lds
    buffer_load_dwordx4 v227, s[12:15], s66 offen offset:1024 lds
    s_add_u32 m0, s68, 49152
    v_mfma_f32_16x16x32_bf16 v[208:211], v[228:231], v[160:163], 0
    v_mfma_f32_16x16x32_bf16 v[212:215], v[228:231], v[164:167], 0
    s_add_u32 s66, s66, 172032
    buffer_load_dwordx4 v2, s[8:11], s65 offen offset:0 lds
    buffer_load_dwordx4 v3, s[8:11], s65 offen offset:1024 lds
    buffer_load_dwordx4 v4, s[8:11], s65 offen offset:2048 lds
    buffer_load_dwordx4 v5, s[8:11], s65 offen offset:3072 lds
    s_add_u32 s65, s65, 128
    s_cmp_eq_u32 s6, 4
    s_cselect_b32 s62, 896, 0
    s_cselect_b32 s63, 1204224, 0
    s_sub_u32 s65, s65, s62
    s_sub_u32 s66, s66, s63
    s_waitcnt lgkmcnt(12)
    v_mfma_f32_32x32x16_bf16 v[128:143], v[20:23], v[168:171], v[128:143]
    s_waitcnt vmcnt(6) lgkmcnt(0)
    s_barrier
    ds_read_b128 v[32:35], v192 offset:24576
    ds_read_b64_tr_b16 v[160:161], v196 offset:24576
    ds_read_b64_tr_b16 v[162:163], v196 offset:24832
    v_mfma_f32_32x32x16_bf16 v[144:159], v[20:23], v[172:175], v[144:159]
    ds_read_b64_tr_b16 v[164:165], v196 offset:25600
    ds_read_b64_tr_b16 v[166:167], v196 offset:25856
    s_add_u32 m0, s69, 90112
    s_nop 0
    buffer_load_dwordx4 v6, s[12:15], s66 offen lds
    v_mfma_f32_32x32x16_bf16 v[128:143], v[24:27], v[176:179], v[128:143]
    ds_read_b128 v[36:39], v193 offset:24576
    ds_read_b64_tr_b16 v[168:169], v197 offset:24576
    ds_read_b64_tr_b16 v[170:171], v197 offset:24832
    ds_read_b64_tr_b16 v[172:173], v197 offset:25600
    ds_read_b64_tr_b16 v[174:175], v197 offset:25856
    v_mfma_f32_32x32x16_bf16 v[144:159], v[24:27], v[180:183], v[144:159]
    buffer_load_dwordx4 v227, s[12:15], s66 offen offset:1024 lds
    s_add_u32 m0, s68, 73728
    s_add_u32 s66, s66, 172032
    s_add_u32 s60, s60, 1
    buffer_load_dwordx4 v2, s[8:11], s65 offen offset:0 lds
    v_mfma_f32_32x32x16_bf16 v[128:143], v[28:31], v[184:187], v[128:143]
    ds_read_b128 v[40:43], v194 offset:24576
    ds_read_b64_tr_b16 v[176:177], v198 offset:24576
    ds_read_b64_tr_b16 v[178:179], v198 offset:24832
    ds_read_b64_tr_b16 v[180:181], v198 offset:25600
    ds_read_b64_tr_b16 v[182:183], v198 offset:25856
    v_mfma_f32_32x32x16_bf16 v[144:159], v[28:31], v[188:191], v[144:159]
    buffer_load_dwordx4 v3, s[8:11], s65 offen offset:1024 lds
    buffer_load_dwordx4 v4, s[8:11], s65 offen offset:2048 lds
    buffer_load_dwordx4 v5, s[8:11], s65 offen offset:3072 lds
    s_add_u32 s65, s65, 128
    s_cmp_eq_u32 s6, 3
    s_cselect_b32 s62, 896, 0
    s_cselect_b32 s63, 1204224, 0
    v_dot2c_f32_bf16 v216, s61, v16
    v_dot2c_f32_bf16 v218, v16, v16
    v_dot2c_f32_bf16 v217, s61, v17
    v_dot2c_f32_bf16 v219, v17, v17
    v_dot2c_f32_bf16 v216, s61, v18
    v_dot2c_f32_bf16 v218, v18, v18
    v_dot2c_f32_bf16 v217, s61, v19
    v_dot2c_f32_bf16 v219, v19, v19
    v_dot2c_f32_bf16 v216, s61, v20
    v_dot2c_f32_bf16 v218, v20, v20
    v_dot2c_f32_bf16 v217, s61, v21
    v_dot2c_f32_bf16 v219, v21, v21
    v_dot2c_f32_bf16 v216, s61, v22
    v_dot2c_f32_bf16 v218, v22, v22
    v_dot2c_f32_bf16 v217, s61, v23
    v_dot2c_f32_bf16 v219, v23, v23
    v_dot2c_f32_bf16 v216, s61, v24
    v_dot2c_f32_bf16 v218, v24, v24
    v_dot2c_f32_bf16 v217, s61, v25
    v_dot2c_f32_bf16 v219, v25, v25
    v_dot2c_f32_bf16 v216, s61, v26
    v_dot2c_f32_bf16 v218, v26, v26
    v_dot2c_f32_bf16 v217, s61, v27
    v_dot2c_f32_bf16 v219, v27, v27
    v_dot2c_f32_bf16 v216, s61, v28
    v_dot2c_f32_bf16 v218, v28, v28
    v_dot2c_f32_bf16 v217, s61, v29
    v_dot2c_f32_bf16 v219, v29, v29
    v_dot2c_f32_bf16 v216, s61, v30
    v_dot2c_f32_bf16 v218, v30, v30
    v_dot2c_f32_bf16 v217, s61, v31
    v_dot2c_f32_bf16 v219, v31, v31
    s_waitcnt lgkmcnt(12)
    v_mfma_f32_32x32x16_bf16 v[128:143], v[32:35], v[160:163], v[128:143]
    ds_read_b128 v[44:47], v195 offset:24576
    ds_read_b64_tr_b16 v[184:185], v199 offset:24576
    ds_read_b64_tr_b16 v[186:187], v199 offset:24832
    ds_read_b64_tr_b16 v[188:189], v199 offset:25600
    ds_read_b64_tr_b16 v[190:191], v199 offset:25856
    s_waitcnt lgkmcnt(14)
    v_mfma_f32_32x32x16_bf16 v[144:159], v[32:35], v[164:167], v[144:159]
    s_sub_u32 s65, s65, s62
    s_sub_u32 s66, s66, s63
    s_add_u32 s54, s55, 0
    s_and_b32 s54, s54, 3
    s_mul_i32 s54, s54, 401408
    v_mfma_f32_16x16x32_bf16 v[208:211], v[228:231], v[160:163], v[208:211]
    v_mfma_f32_16x16x32_bf16 v[212:215], v[228:231], v[164:167], v[212:215]
    s_add_u32 s54, s54, s53
    s_add_u32 m0, s52, 98304
    s_add_u32 s59, s54, 0
    buffer_load_dwordx4 v254, s[20:23], s59 offen  lds
    s_add_u32 m0, s52, 102400
    s_add_u32 s59, s54, 57344
    buffer_load_dwordx4 v254, s[20:23], s59 offen  lds
    s_add_u32 m0, s52, 106496
    s_add_u32 s59, s54, 114688
    buffer_load_dwordx4 v254, s[20:23], s59 offen  lds
    s_add_u32 m0, s52, 110592
    s_add_u32 s59, s54, 172032
    buffer_load_dwordx4 v254, s[20:23], s59 offen  lds
    s_add_u32 m0, s52, 114688
    s_add_u32 s59, s54, 229376
    buffer_load_dwordx4 v254, s[20:23], s59 offen  lds
    s_add_u32 m0, s52, 118784
    s_add_u32 s59, s54, 286720
    buffer_load_dwordx4 v254, s[20:23], s59 offen  lds
    s_add_u32 m0, s52, 122880
    s_add_u32 s59, s54, 344064
    buffer_load_dwordx4 v254, s[20:23], s59 offen  lds
    s_waitcnt lgkmcnt(12)
    v_mfma_f32_32x32x16_bf16 v[128:143], v[36:39], v[168:171], v[128:143]
    s_waitcnt vmcnt(13) lgkmcnt(0)
    s_barrier
    ds_read_b128 v[48:51], v200 offset:0
    ds_read_b64_tr_b16 v[160:161], v204 offset:0
    ds_read_b64_tr_b16 v[162:163], v204 offset:256
    v_mfma_f32_32x32x16_bf16 v[144:159], v[36:39], v[172:175], v[144:159]
    ds_read_b64_tr_b16 v[164:165], v204 offset:1024
    ds_read_b64_tr_b16 v[166:167], v204 offset:1280
    s_mul_i32 s64, s60, 0x9e3779b1
    v_mov_b32 v14, s60
    v_and_b32_e64 v224, 7, v1
    v_mfma_f32_32x32x16_bf16 v[128:143], v[40:43], v[176:179], v[128:143]
    ds_read_b128 v[52:55], v201 offset:0
    ds_read_b64_tr_b16 v[168:169], v205 offset:0
    ds_read_b64_tr_b16 v[170:171], v205 offset:256
    ds_read_b64_tr_b16 v[172:173], v205 offset:1024
    ds_read_b64_tr_b16 v[174:175], v205 offset:1280
    v_mfma_f32_32x32x16_bf16 v[144:159], v[40:43], v[180:183], v[144:159]
    s_add_u32 m0, s69, 16384
    s_nop 0
    buffer_load_dwordx4 v6, s[12:15], s66 offen lds
    buffer_load_dwordx4 v227, s[12:15], s66 offen offset:1024 lds
    s_add_u32 m0, s68, 0
    v_mfma_f32_32x32x16_bf16 v[128:143], v[44:47], v[184:187], v[128:143]
    ds_read_b128 v[56:59], v202 offset:0
    ds_read_b64_tr_b16 v[176:177], v206 offset:0
    ds_read_b64_tr_b16 v[178:179], v206 offset:256
    ds_read_b64_tr_b16 v[180:181], v206 offset:1024
    ds_read_b64_tr_b16 v[182:183], v206 offset:1280
    v_mfma_f32_32x32x16_bf16 v[144:159], v[44:47], v[188:191], v[144:159]
    v_lshlrev_b32 v224, 2, v224
    s_add_u32 s66, s66, 172032
    buffer_load_dwordx4 v2, s[8:11], s65 offen offset:0 lds
    buffer_load_dwordx4 v3, s[8:11], s65 offen offset:1024 lds
    buffer_load_dwordx4 v4, s[8:11], s65 offen offset:2048 lds
    v_dot2c_f32_bf16 v216, s61, v32
    v_dot2c_f32_bf16 v218, v32, v32
    v_dot2c_f32_bf16 v217, s61, v33
    v_dot2c_f32_bf16 v219, v33, v33
    v_dot2c_f32_bf16 v216, s61, v34
    v_dot2c_f32_bf16 v218, v34, v34
    v_dot2c_f32_bf16 v217, s61, v35
    v_dot2c_f32_bf16 v219, v35, v35
    v_dot2c_f32_bf16 v216, s61, v36
    v_dot2c_f32_bf16 v218, v36, v36
    v_dot2c_f32_bf16 v217, s61, v37
    v_dot2c_f32_bf16 v219, v37, v37
    v_dot2c_f32_bf16 v216, s61, v38
    v_dot2c_f32_bf16 v218, v38, v38
    v_dot2c_f32_bf16 v217, s61, v39
    v_dot2c_f32_bf16 v219, v39, v39
    v_dot2c_f32_bf16 v216, s61, v40
    v_dot2c_f32_bf16 v218, v40, v40
    v_dot2c_f32_bf16 v217, s61, v41
    v_dot2c_f32_bf16 v219, v41, v41
    v_dot2c_f32_bf16 v216, s61, v42
    v_dot2c_f32_bf16 v218, v42, v42
    v_dot2c_f32_bf16 v217, s61, v43
    v_dot2c_f32_bf16 v219, v43, v43
    v_dot2c_f32_bf16 v216, s61, v44
    v_dot2c_f32_bf16 v218, v44, v44
    v_dot2c_f32_bf16 v217, s61, v45
    v_dot2c_f32_bf16 v219, v45, v45
    v_dot2c_f32_bf16 v216, s61, v46
    v_dot2c_f32_bf16 v218, v46, v46
    v_dot2c_f32_bf16 v217, s61, v47
    v_dot2c_f32_bf16 v219, v47, v47
    s_waitcnt lgkmcnt(12)
    v_mfma_f32_32x32x16_bf16 v[128:143], v[48:51], v[160:163], v[128:143]
    ds_read_b128 v[60:63], v203 offset:0
    ds_read_b64_tr_b16 v[184:185], v207 offset:0
    ds_read_b64_tr_b16 v[186:187], v207 offset:256
    ds_read_b64_tr_b16 v[188:189], v207 offset:1024
    ds_read_b64_tr_b16 v[190:191], v207 offset:1280
    s_waitcnt lgkmcnt(14)
    v_mfma_f32_32x32x16_bf16 v[144:159], v[48:51], v[164:167], v[144:159]
    v_lshrrev_b32 v224, v224, s64
    buffer_load_dwordx4 v5, s[8:11], s65 offen offset:3072 lds
    s_add_u32 s65, s65, 128
    s_cmp_eq_u32 s6, 2
    s_cselect_b32 s62, 896, 0
    s_cselect_b32 s63, 1204224, 0
    v_mfma_f32_16x16x32_bf16 v[208:211], v[228:231], v[160:163], v[208:211]
    v_mfma_f32_16x16x32_bf16 v[212:215], v[228:231], v[164:167], v[212:215]
    s_sub_u32 s65, s65, s62
    s_sub_u32 s66, s66, s63
    v_and_b32_e64 v224, 15, v224
    v_lshl_or_b32 v224, v224, 15, v224
    v_lshrrev_b32_e64 v225, 2, v224
    s_waitcnt lgkmcnt(12)
    v_mfma_f32_32x32x16_bf16 v[128:143], v[52:55], v[168:171], v[128:143]
    s_waitcnt vmcnt(13) lgkmcnt(0)
    s_barrier
    ds_read_b128 v[64:67], v200 offset:24576
    ds_read_b64_tr_b16 v[160:161], v204 offset:24576
    ds_read_b64_tr_b16 v[162:163], v204 offset:24832
    v_mfma_f32_32x32x16_bf16 v[144:159], v[52:55], v[172:175], v[144:159]
    ds_read_b64_tr_b16 v[164:165], v204 offset:25600
    ds_read_b64_tr_b16 v[166:167], v204 offset:25856
    s_add_u32 m0, s69, 40960
    s_nop 0
    buffer_load_dwordx4 v6, s[12:15], s66 offen lds
    v_mfma_f32_32x32x16_bf16 v[128:143], v[56:59], v[176:179], v[128:143]
    ds_read_b128 v[68:71], v201 offset:24576
    ds_read_b64_tr_b16 v[168:169], v205 offset:24576
    ds_read_b64_tr_b16 v[170:171], v205 offset:24832
    ds_read_b64_tr_b16 v[172:173], v205 offset:25600
    ds_read_b64_tr_b16 v[174:175], v205 offset:25856
    v_mfma_f32_32x32x16_bf16 v[144:159], v[56:59], v[180:183], v[144:159]
    buffer_load_dwordx4 v227, s[12:15], s66 offen offset:1024 lds
    s_add_u32 m0, s68, 24576
    s_add_u32 s66, s66, 172032
    v_and_b32 v224, 0x10001, v224
    v_and_b32 v225, 0x10001, v225
    v_mfma_f32_32x32x16_bf16 v[128:143], v[60:63], v[184:187], v[128:143]
    ds_read_b128 v[72:75], v202 offset:24576
    ds_read_b64_tr_b16 v[176:177], v206 offset:24576
    ds_read_b64_tr_b16 v[178:179], v206 offset:24832
    ds_read_b64_tr_b16 v[180:181], v206 offset:25600
    ds_read_b64_tr_b16 v[182:183], v206 offset:25856
    v_mfma_f32_32x32x16_bf16 v[144:159], v[60:63], v[188:191], v[144:159]
    buffer_load_dwordx4 v2, s[8:11], s65 offen offset:0 lds
    buffer_load_dwordx4 v3, s[8:11], s65 offen offset:1024 lds
    buffer_load_dwordx4 v4, s[8:11], s65 offen offset:2048 lds
    buffer_load_dwordx4 v5, s[8:11], s65 offen offset:3072 lds
    v_dot2c_f32_bf16 v216, s61, v48
    v_dot2c_f32_bf16 v218, v48, v48
    v_dot2c_f32_bf16 v217, s61, v49
    v_dot2c_f32_bf16 v219, v49, v49
    v_dot2c_f32_bf16 v216, s61, v50
    v_dot2c_f32_bf16 v218, v50, v50
    v_dot2c_f32_bf16 v217, s61, v51
    v_dot2c_f32_bf16 v219, v51, v51
    v_dot2c_f32_bf16 v216, s61, v52
    v_dot2c_f32_bf16 v218, v52, v52
    v_dot2c_f32_bf16 v217, s61, v53
    v_dot2c_f32_bf16 v219, v53, v53
    v_dot2c_f32_bf16 v216, s61, v54
    v_dot2c_f32_bf16 v218, v54, v54
    v_dot2c_f32_bf16 v217, s61, v55
    v_dot2c_f32_bf16 v219, v55, v55
    v_dot2c_f32_bf16 v216, s61, v56
    v_dot2c_f32_bf16 v218, v56, v56
    v_dot2c_f32_bf16 v217, s61, v57
    v_dot2c_f32_bf16 v219, v57, v57
    v_dot2c_f32_bf16 v216, s61, v58
    v_dot2c_f32_bf16 v218, v58, v58
    v_dot2c_f32_bf16 v217, s61, v59
    v_dot2c_f32_bf16 v219, v59, v59
    v_dot2c_f32_bf16 v216, s61, v60
    v_dot2c_f32_bf16 v218, v60, v60
    v_dot2c_f32_bf16 v217, s61, v61
    v_dot2c_f32_bf16 v219, v61, v61
    v_dot2c_f32_bf16 v216, s61, v62
    v_dot2c_f32_bf16 v218, v62, v62
    v_dot2c_f32_bf16 v217, s61, v63
    v_dot2c_f32_bf16 v219, v63, v63
    s_waitcnt lgkmcnt(12)
    v_mfma_f32_32x32x16_bf16 v[128:143], v[64:67], v[160:163], v[128:143]
    ds_read_b128 v[76:79], v203 offset:24576
    ds_read_b64_tr_b16 v[184:185], v207 offset:24576
    ds_read_b64_tr_b16 v[186:187], v207 offset:24832
    ds_read_b64_tr_b16 v[188:189], v207 offset:25600
    ds_read_b64_tr_b16 v[190:191], v207 offset:25856
    s_waitcnt lgkmcnt(14)
    v_mfma_f32_32x32x16_bf16 v[144:159], v[64:67], v[164:167], v[144:159]
    s_add_u32 s65, s65, 128
    s_cmp_eq_u32 s6, 1
    s_cselect_b32 s62, 896, 0
    s_cselect_b32 s63, 1204224, 0
    s_sub_u32 s65, s65, s62
    v_mfma_f32_16x16x32_bf16 v[208:211], v[228:231], v[160:163], v[208:211]
    v_mfma_f32_16x16x32_bf16 v[212:215], v[228:231], v[164:167], v[212:215]
    s_sub_u32 s66, s66, s63
    s_waitcnt lgkmcnt(12)
    v_mfma_f32_32x32x16_bf16 v[128:143], v[68:71], v[168:171], v[128:143]
    s_waitcnt vmcnt(6) lgkmcnt(0)
    s_barrier
    ds_read_b128 v[80:83], v192 offset:0
    ds_read_b64_tr_b16 v[160:161], v196 offset:0
    ds_read_b64_tr_b16 v[162:163], v196 offset:256
    v_mfma_f32_32x32x16_bf16 v[144:159], v[68:71], v[172:175], v[144:159]
    ds_read_b64_tr_b16 v[164:165], v196 offset:1024
    ds_read_b64_tr_b16 v[166:167], v196 offset:1280
    ds_read_b64_tr_b16 a[0:1], v236 offset:0
    ds_read_b64_tr_b16 a[2:3], v236 offset:2048
    s_add_u32 m0, s69, 65536
    v_mfma_f32_32x32x16_bf16 v[128:143], v[72:75], v[176:179], v[128:143]
    ds_read_b128 v[84:87], v193 offset:0
    ds_read_b64_tr_b16 v[168:169], v197 offset:0
    ds_read_b64_tr_b16 v[170:171], v197 offset:256
    ds_read_b64_tr_b16 v[172:173], v197 offset:1024
    ds_read_b64_tr_b16 v[174:175], v197 offset:1280
    v_mfma_f32_32x32x16_bf16 v[144:159], v[72:75], v[180:183], v[144:159]
    buffer_load_dwordx4 v6, s[12:15], s66 offen lds
    ds_read_b64_tr_b16 a[4:5], v236 offset:4096
    ds_read_b64_tr_b16 a[6:7], v236 offset:6144
    buffer_load_dwordx4 v227, s[12:15], s66 offen offset:1024 lds
    s_add_u32 m0, s68, 49152
    v_mfma_f32_32x32x16_bf16 v[128:143], v[76:79], v[184:187], v[128:143]
    ds_read_b128 v[88:91], v194 offset:0
    ds_read_b64_tr_b16 v[176:177], v198 offset:0
    ds_read_b64_tr_b16 v[178:179], v198 offset:256
    ds_read_b64_tr_b16 v[180:181], v198 offset:1024
    ds_read_b64_tr_b16 v[182:183], v198 offset:1280
    v_mfma_f32_32x32x16_bf16 v[144:159], v[76:79], v[188:191], v[144:159]
    ds_read_b64_tr_b16 a[8:9], v236 offset:8192
    ds_read_b64_tr_b16 a[10:11], v236 offset:10240
    s_add_u32 s66, s66, 172032
    s_lshl_b32 s64, s3, 8
    buffer_load_dwordx4 v2, s[8:11], s65 offen offset:0 lds
    v_dot2c_f32_bf16 v216, s61, v64
    v_dot2c_f32_bf16 v218, v64, v64
    v_dot2c_f32_bf16 v217, s61, v65
    v_dot2c_f32_bf16 v219, v65, v65
    v_dot2c_f32_bf16 v216, s61, v66
    v_dot2c_f32_bf16 v218, v66, v66
    v_dot2c_f32_bf16 v217, s61, v67
    v_dot2c_f32_bf16 v219, v67, v67
    v_dot2c_f32_bf16 v216, s61, v68
    v_dot2c_f32_bf16 v218, v68, v68
    v_dot2c_f32_bf16 v217, s61, v69
    v_dot2c_f32_bf16 v219, v69, v69
    v_dot2c_f32_bf16 v216, s61, v70
    v_dot2c_f32_bf16 v218, v70, v70
    v_dot2c_f32_bf16 v217, s61, v71
    v_dot2c_f32_bf16 v219, v71, v71
    v_dot2c_f32_bf16 v216, s61, v72
    v_dot2c_f32_bf16 v218, v72, v72
    v_dot2c_f32_bf16 v217, s61, v73
    v_dot2c_f32_bf16 v219, v73, v73
    v_dot2c_f32_bf16 v216, s61, v74
    v_dot2c_f32_bf16 v218, v74, v74
    v_dot2c_f32_bf16 v217, s61, v75
    v_dot2c_f32_bf16 v219, v75, v75
    v_dot2c_f32_bf16 v216, s61, v76
    v_dot2c_f32_bf16 v218, v76, v76
    v_dot2c_f32_bf16 v217, s61, v77
    v_dot2c_f32_bf16 v219, v77, v77
    v_dot2c_f32_bf16 v216, s61, v78
    v_dot2c_f32_bf16 v218, v78, v78
    v_dot2c_f32_bf16 v217, s61, v79
    v_dot2c_f32_bf16 v219, v79, v79
    s_waitcnt lgkmcnt(14)
    v_mfma_f32_32x32x16_bf16 v[128:143], v[80:83], v[160:163], v[128:143]
    ds_read_b128 v[92:95], v195 offset:0
    ds_read_b64_tr_b16 v[184:185], v199 offset:0
    ds_read_b64_tr_b16 v[186:187], v199 offset:256
    ds_read_b64_tr_b16 v[188:189], v199 offset:1024
    ds_read_b64_tr_b16 v[190:191], v199 offset:1280
    v_mfma_f32_32x32x16_bf16 v[144:159], v[80:83], v[164:167], v[144:159]
    ds_read_b64_tr_b16 a[12:13], v236 offset:12288
    ds_read_b64_tr_b16 a[14:15], v236 offset:14336
    buffer_load_dwordx4 v3, s[8:11], s65 offen offset:1024 lds
    buffer_load_dwordx4 v4, s[8:11], s65 offen offset:2048 lds
    ds_read_b64_tr_b16 a[16:17], v236 offset:16384
    ds_read_b64_tr_b16 a[18:19], v236 offset:18432
    v_mfma_f32_16x16x32_bf16 v[208:211], v[228:231], v[160:163], v[208:211]
    v_mfma_f32_16x16x32_bf16 v[212:215], v[228:231], v[164:167], v[212:215]
    ds_read_b64_tr_b16 a[20:21], v236 offset:20480
    ds_read_b64_tr_b16 a[22:23], v236 offset:22528
    ds_read_b64_tr_b16 a[24:25], v236 offset:24576
    ds_read_b64_tr_b16 a[26:27], v236 offset:26624
    buffer_load_dwordx4 v5, s[8:11], s65 offen offset:3072 lds
    s_add_u32 s65, s65, 128
    s_cmp_eq_u32 s6, 0
    s_cselect_b32 s62, 896, 0
    s_cselect_b32 s63, 1204224, 0
    s_sub_u32 s65, s65, s62
    s_sub_u32 s66, s66, s63
    s_waitcnt lgkmcnt(14)
    v_mfma_f32_32x32x16_bf16 v[128:143], v[84:87], v[168:171], v[128:143]
    s_waitcnt vmcnt(6) lgkmcnt(0)
    s_barrier
    ds_read_b128 v[96:99], v192 offset:24576
    ds_read_b64_tr_b16 v[160:161], v196 offset:24576
    ds_read_b64_tr_b16 v[162:163], v196 offset:24832
    v_mfma_f32_32x32x16_bf16 v[144:159], v[84:87], v[172:175], v[144:159]
    ds_read_b64_tr_b16 v[164:165], v196 offset:25600
    ds_read_b64_tr_b16 v[166:167], v196 offset:25856
    s_add_u32 s64, s64, 160768
    v_lshl_add_u32 v7, v10, 2, s64
    buffer_load_dword v237, v248, s[28:31], 0 offen sc1
    v_mfma_f32_32x32x16_bf16 v[128:143], v[88:91], v[176:179], v[128:143]
    ds_read_b128 v[100:103], v193 offset:24576
    ds_read_b64_tr_b16 v[168:169], v197 offset:24576
    ds_read_b64_tr_b16 v[170:171], v197 offset:24832
    ds_read_b64_tr_b16 v[172:173], v197 offset:25600
    ds_read_b64_tr_b16 v[174:175], v197 offset:25856
    v_mfma_f32_32x32x16_bf16 v[144:159], v[88:91], v[180:183], v[144:159]
    buffer_load_dword v237, v249, s[16:19], 0 offen
    buffer_load_dword v237, v250, s[24:27], 0 offen
    v_lshl_add_u32 v12, v11, 4, s64
    s_sub_u32 s66, s66, 768
    s_add_u32 m0, s52, 98304
    v_mfma_f32_32x32x16_bf16 v[128:143], v[92:95], v[184:187], v[128:143]
    ds_read_b128 v[104:107], v194 offset:24576
    ds_read_b64_tr_b16 v[176:177], v198 offset:24576
    ds_read_b64_tr_b16 v[178:179], v198 offset:24832
    ds_read_b64_tr_b16 v[180:181], v198 offset:25600
    ds_read_b64_tr_b16 v[182:183], v198 offset:25856
    v_mfma_f32_32x32x16_bf16 v[144:159], v[92:95], v[188:191], v[144:159]
    buffer_load_dwordx4 v227, s[12:15], s66 offen lds
    s_add_u32 s66, s66, 172032
    v_lshlrev_b32_e64 v9, 4, v10
    s_cmp_eq_u32 s6, 6
    s_cselect_b32 s62, 1204224, 0
    v_dot2c_f32_bf16 v216, s61, v80
    v_dot2c_f32_bf16 v218, v80, v80
    v_dot2c_f32_bf16 v217, s61, v81
    v_dot2c_f32_bf16 v219, v81, v81
    v_dot2c_f32_bf16 v216, s61, v82
    v_dot2c_f32_bf16 v218, v82, v82
    v_dot2c_f32_bf16 v217, s61, v83
    v_dot2c_f32_bf16 v219, v83, v83
    v_dot2c_f32_bf16 v216, s61, v84
    v_dot2c_f32_bf16 v218, v84, v84
    v_dot2c_f32_bf16 v217, s61, v85
    v_dot2c_f32_bf16 v219, v85, v85
    v_dot2c_f32_bf16 v216, s61, v86
    v_dot2c_f32_bf16 v218, v86, v86
    v_dot2c_f32_bf16 v217, s61, v87
    v_dot2c_f32_bf16 v219, v87, v87
    v_dot2c_f32_bf16 v216, s61, v88
    v_dot2c_f32_bf16 v218, v88, v88
    v_dot2c_f32_bf16 v217, s61, v89
    v_dot2c_f32_bf16 v219, v89, v89
    v_dot2c_f32_bf16 v216, s61, v90
    v_dot2c_f32_bf16 v218, v90, v90
    v_dot2c_f32_bf16 v217, s61, v91
    v_dot2c_f32_bf16 v219, v91, v91
    v_dot2c_f32_bf16 v216, s61, v92
    v_dot2c_f32_bf16 v218, v92, v92
    v_dot2c_f32_bf16 v217, s61, v93
    v_dot2c_f32_bf16 v219, v93, v93
    v_dot2c_f32_bf16 v216, s61, v94
    v_dot2c_f32_bf16 v218, v94, v94
    v_dot2c_f32_bf16 v217, s61, v95
    v_dot2c_f32_bf16 v219, v95, v95
    s_waitcnt lgkmcnt(12)
    v_mfma_f32_32x32x16_bf16 v[128:143], v[96:99], v[160:163], v[128:143]
    ds_read_b128 v[108:111], v195 offset:24576
    ds_read_b64_tr_b16 v[184:185], v199 offset:24576
    ds_read_b64_tr_b16 v[186:187], v199 offset:24832
    ds_read_b64_tr_b16 v[188:189], v199 offset:25600
    ds_read_b64_tr_b16 v[190:191], v199 offset:25856
    s_waitcnt lgkmcnt(14)
    v_mfma_f32_32x32x16_bf16 v[144:159], v[96:99], v[164:167], v[144:159]
    s_sub_u32 s66, s66, s62
    s_add_u32 m0, s52, 102400
    s_nop 0
    buffer_load_dwordx4 v227, s[12:15], s66 offen lds
    v_add_u32 v9, 159744, v9
    v_mfma_f32_16x16x32_bf16 v[208:211], v[228:231], v[160:163], v[208:211]
    v_mfma_f32_16x16x32_bf16 v[212:215], v[228:231], v[164:167], v[212:215]
    s_add_u32 s66, s66, 172032
    s_cmp_eq_u32 s6, 5
    s_cselect_b32 s62, 1204224, 0
    s_sub_u32 s66, s66, s62
    v_lshl_add_u32 v8, s3, 2, v9
    s_waitcnt lgkmcnt(12)
    v_mfma_f32_32x32x16_bf16 v[128:143], v[100:103], v[168:171], v[128:143]
    s_waitcnt vmcnt(5) lgkmcnt(0)
    s_barrier
    ds_read_b128 v[112:115], v200 offset:0
    ds_read_b128 v[116:119], v201 offset:0
    ds_read_b128 v[120:123], v202 offset:0
    v_mfma_f32_32x32x16_bf16 v[144:159], v[100:103], v[172:175], v[144:159]
    ds_read_b128 v[124:127], v203 offset:0
    ds_read_b64_tr_b16 v[160:161], v204 offset:0
    ds_read_b64_tr_b16 v[162:163], v204 offset:256
    ds_read_b64_tr_b16 v[164:165], v204 offset:1024
    ds_read_b64_tr_b16 v[166:167], v204 offset:1280
    v_mfma_f32_32x32x16_bf16 v[128:143], v[104:107], v[176:179], v[128:143]
    ds_read_b64_tr_b16 v[168:169], v205 offset:0
    ds_read_b64_tr_b16 v[170:171], v205 offset:256
    ds_read_b64_tr_b16 v[172:173], v205 offset:1024
    ds_read_b64_tr_b16 v[174:175], v205 offset:1280
    s_add_u32 m0, s52, 106496
    v_mfma_f32_32x32x16_bf16 v[144:159], v[104:107], v[180:183], v[144:159]
    buffer_load_dwordx4 v227, s[12:15], s66 offen lds
    s_add_u32 s66, s66, 172032
    s_cmp_eq_u32 s6, 4
    s_cselect_b32 s62, 1204224, 0
    s_sub_u32 s66, s66, s62
    v_dot2c_f32_bf16 v216, s61, v96
    v_dot2c_f32_bf16 v218, v96, v96
    v_dot2c_f32_bf16 v217, s61, v97
    v_dot2c_f32_bf16 v219, v97, v97
    v_dot2c_f32_bf16 v216, s61, v98
    v_dot2c_f32_bf16 v218, v98, v98
    v_dot2c_f32_bf16 v217, s61, v99
    v_dot2c_f32_bf16 v219, v99, v99
    v_dot2c_f32_bf16 v216, s61, v100
    v_dot2c_f32_bf16 v218, v100, v100
    v_dot2c_f32_bf16 v217, s61, v101
    v_dot2c_f32_bf16 v219, v101, v101
    v_dot2c_f32_bf16 v216, s61, v102
    v_dot2c_f32_bf16 v218, v102, v102
    v_dot2c_f32_bf16 v217, s61, v103
    v_dot2c_f32_bf16 v219, v103, v103
    v_dot2c_f32_bf16 v216, s61, v104
    v_dot2c_f32_bf16 v218, v104, v104
    v_dot2c_f32_bf16 v217, s61, v105
    v_dot2c_f32_bf16 v219, v105, v105
    v_dot2c_f32_bf16 v216, s61, v106
    v_dot2c_f32_bf16 v218, v106, v106
    v_dot2c_f32_bf16 v217, s61, v107
    v_dot2c_f32_bf16 v219, v107, v107
    v_dot2c_f32_bf16 v216, s61, v108
    v_dot2c_f32_bf16 v218, v108, v108
    v_dot2c_f32_bf16 v217, s61, v109
    v_dot2c_f32_bf16 v219, v109, v109
    v_dot2c_f32_bf16 v216, s61, v110
    v_dot2c_f32_bf16 v218, v110, v110
    v_dot2c_f32_bf16 v217, s61, v111
    v_dot2c_f32_bf16 v219, v111, v111
    s_waitcnt lgkmcnt(11)
    v_dot2c_f32_bf16 v216, s61, v112
    v_dot2c_f32_bf16 v218, v112, v112
    v_dot2c_f32_bf16 v217, s61, v113
    v_dot2c_f32_bf16 v219, v113, v113
    v_dot2c_f32_bf16 v216, s61, v114
    v_dot2c_f32_bf16 v218, v114, v114
    v_dot2c_f32_bf16 v217, s61, v115
    v_dot2c_f32_bf16 v219, v115, v115
    s_waitcnt lgkmcnt(10)
    v_dot2c_f32_bf16 v216, s61, v116
    v_dot2c_f32_bf16 v218, v116, v116
    v_dot2c_f32_bf16 v217, s61, v117
    v_dot2c_f32_bf16 v219, v117, v117
    v_dot2c_f32_bf16 v216, s61, v118
    v_dot2c_f32_bf16 v218, v118, v118
    v_dot2c_f32_bf16 v217, s61, v119
    v_dot2c_f32_bf16 v219, v119, v119
    s_waitcnt lgkmcnt(9)
    v_dot2c_f32_bf16 v216, s61, v120
    v_dot2c_f32_bf16 v218, v120, v120
    v_dot2c_f32_bf16 v217, s61, v121
    v_dot2c_f32_bf16 v219, v121, v121
    v_dot2c_f32_bf16 v216, s61, v122
    v_dot2c_f32_bf16 v218, v122, v122
    v_dot2c_f32_bf16 v217, s61, v123
    v_dot2c_f32_bf16 v219, v123, v123
    s_waitcnt lgkmcnt(8)
    v_dot2c_f32_bf16 v216, s61, v124
    v_dot2c_f32_bf16 v218, v124, v124
    v_dot2c_f32_bf16 v217, s61, v125
    v_dot2c_f32_bf16 v219, v125, v125
    v_dot2c_f32_bf16 v216, s61, v126
    v_dot2c_f32_bf16 v218, v126, v126
    v_dot2c_f32_bf16 v217, s61, v127
    v_dot2c_f32_bf16 v219, v127, v127
    v_mfma_f32_32x32x16_bf16 v[128:143], v[108:111], v[184:187], v[128:143]
    ds_read_b64_tr_b16 v[176:177], v206 offset:0
    ds_read_b64_tr_b16 v[178:179], v206 offset:256
    ds_read_b64_tr_b16 v[180:181], v206 offset:1024
    ds_read_b64_tr_b16 v[182:183], v206 offset:1280
    v_add_f32_e64 v216, v216, v217
    v_mfma_f32_32x32x16_bf16 v[144:159], v[108:111], v[188:191], v[144:159]
    v_add_f32 v218, v218, v219
    v_mov_b32 v217, v216
    v_mov_b32 v219, v218
    v_and_b32 v13, 16, v1
    v_cmp_ne_u32 vcc, 0, v13
    s_waitcnt lgkmcnt(10)
    v_mfma_f32_32x32x16_bf16 v[128:143], v[112:115], v[160:163], v[128:143]
    ds_read_b64_tr_b16 v[184:185], v207 offset:0
    ds_read_b64_tr_b16 v[186:187], v207 offset:256
    ds_read_b64_tr_b16 v[188:189], v207 offset:1024
    ds_read_b64_tr_b16 v[190:191], v207 offset:1280
    v_permlane32_swap_b32 v216, v217
    s_waitcnt lgkmcnt(12)
    v_mfma_f32_32x32x16_bf16 v[144:159], v[112:115], v[164:167], v[144:159]
    v_permlane32_swap_b32 v218, v219
    v_add_f32 v216, v216, v217
    v_add_f32_e64 v218, v218, v219
    v_mul_f32 v220, 0x3b124925, v216
    v_mul_f32 v221, 0x3b124925, v218
    v_mfma_f32_16x16x32_bf16 v[208:211], v[228:231], v[160:163], v[208:211]
    v_mfma_f32_16x16x32_bf16 v[212:215], v[228:231], v[164:167], v[212:215]
    v_fma_f32 v221, -v220, v220, v221
    v_max_f32_e64 v221, 0, v221
    v_add_f32 v221, 0x3727c5ac, v221
    v_rsq_f32 v221, v221
    ds_write_b32 v7, v220
    s_waitcnt lgkmcnt(11)
    v_mfma_f32_32x32x16_bf16 v[128:143], v[116:119], v[168:171], v[128:143]
    ds_write_b32 v7, v221 offset:128
    s_add_u32 m0, s52, 110592
    s_nop 0
    buffer_load_dwordx4 v227, s[12:15], s66 offen lds
    s_add_u32 s66, s66, 172032
    s_waitcnt lgkmcnt(10)
    v_mfma_f32_32x32x16_bf16 v[144:159], v[116:119], v[172:175], v[144:159]
    v_cndmask_b32_e64 v232, v208, v209, vcc
    v_cndmask_b32 v233, v212, v213, vcc
    ds_write_b32 v8, v232
    ds_write_b32 v8, v233 offset:512
    s_cmp_eq_u32 s6, 3
    s_cselect_b32 s62, 1204224, 0
    s_waitcnt lgkmcnt(10)
    v_mfma_f32_32x32x16_bf16 v[128:143], v[120:123], v[176:179], v[128:143]
    s_sub_u32 s66, s66, s62
    s_add_u32 m0, s52, 114688
    s_nop 0
    buffer_load_dwordx4 v227, s[12:15], s66 offen lds
    s_add_u32 s66, s66, 172032
    s_waitcnt lgkmcnt(8)
    v_mfma_f32_32x32x16_bf16 v[144:159], v[120:123], v[180:183], v[144:159]
    s_waitcnt lgkmcnt(0)
    s_barrier
    ds_read_b128 v[208:211], v9
    ds_read_b128 v[212:215], v9 offset:512
    ds_read_b128 v[192:195], v12 offset:0
    v_mfma_f32_32x32x16_bf16 v[128:143], v[124:127], v[184:187], v[128:143]
    s_cmp_eq_u32 s6, 2
    s_cselect_b32 s62, 1204224, 0
    s_sub_u32 s66, s66, s62
    s_add_u32 m0, s52, 118784
    s_nop 0
    buffer_load_dwordx4 v227, s[12:15], s66 offen lds
    s_add_u32 s66, s66, 172032
    s_cmp_eq_u32 s6, 1
    s_cselect_b32 s62, 1204224, 0
    s_sub_u32 s66, s66, s62
    s_add_u32 m0, s52, 122880
    s_nop 0
    buffer_load_dwordx4 v227, s[12:15], s66 offen lds
    v_mfma_f32_32x32x16_bf16 v[144:159], v[124:127], v[188:191], v[144:159]
    ds_read_b128 v[240:243], v12 offset:128
    ds_read_b128 v[196:199], v12 offset:32
    ds_read_b128 v[244:247], v12 offset:160
    ds_read_b128 v[200:203], v12 offset:64
    ds_read_b128 v[248:251], v12 offset:192
    ds_read_b128 v[204:207], v12 offset:96
    ds_read_b128 v[252:255], v12 offset:224
    v_lshlrev_b32_e64 v12, 4, v1
    s_add_u32 s62, s68, 73728
    v_add_u32_e64 v13, s62, v12
    s_add_u32 s62, s52, 73728
    v_add_u32_e64 v238, s62, v12
    s_waitcnt lgkmcnt(9)
    v_pk_add_f32 v[208:209], v[208:209], v[210:211]
    s_waitcnt lgkmcnt(8)
    v_pk_add_f32 v[212:213], v[212:213], v[214:215]
    v_cmp_eq_u32 s[48:49], 28, v10
    v_mov_b32 v216, s61
    v_add_f32 v222, v208, v209
    v_cndmask_b32 v216, 0, v216, s[48:49]
    v_add_f32_e64 v223, v212, v213
    v_accvgpr_read_b32 v3, a225
    s_waitcnt lgkmcnt(7)
    v_pk_fma_f32 v[128:129], v[192:193], v[222:223], v[128:129] op_sel:[0,0,0] op_sel_hi:[1,0,1] neg_lo:[1,0,0] neg_hi:[1,0,0]
    v_pk_fma_f32 v[144:145], v[192:193], v[222:223], v[144:145] op_sel:[0,1,0] op_sel_hi:[1,1,1] neg_lo:[1,0,0] neg_hi:[1,0,0]
    s_waitcnt lgkmcnt(6)
    v_pk_fma_f32 v[128:129], v[128:129], v[240:241], s[44:45]
    v_pk_mul_f32 v[144:145], v[144:145], v[240:241]
    v_pk_mul_f32 v[232:233], v[128:129], s[46:47]
    v_max_f32 v128, s44, v128
    v_max_f32 v129, s44, v129
    v_exp_f32 v232, v232 clamp
    v_exp_f32 v233, v233 clamp
    v_cvt_pk_bf16_f32 v168, v144, v145
    s_add_u32 s54, s55, 1
    s_and_b32 s54, s54, 3
    s_mul_i32 s54, s54, 401408
    s_add_u32 s54, s54, s53
    s_add_u32 m0, s52, 126976
    s_add_u32 s59, s54, 0
    buffer_load_dwordx4 v3, s[20:23], s59 offen  lds
    v_pk_fma_f32 v[130:131], v[194:195], v[222:223], v[130:131] op_sel:[0,0,0] op_sel_hi:[1,0,1] neg_lo:[1,0,0] neg_hi:[1,0,0]
    v_pk_fma_f32 v[146:147], v[194:195], v[222:223], v[146:147] op_sel:[0,1,0] op_sel_hi:[1,1,1] neg_lo:[1,0,0] neg_hi:[1,0,0]
    v_pk_fma_f32 v[130:131], v[130:131], v[242:243], s[44:45]
    v_pk_mul_f32 v[146:147], v[146:147], v[242:243]
    v_pk_add_f32 v[128:129], v[128:129], v[232:233]
    v_cvt_pk_bf16_f32 v160, v128, v129
    v_pk_mul_f32 v[234:235], v[130:131], s[46:47]
    v_max_f32 v130, s44, v130
    v_max_f32 v131, s44, v131
    v_exp_f32 v234, v234 clamp
    v_exp_f32 v235, v235 clamp
    v_cvt_pk_bf16_f32 v169, v146, v147
    s_waitcnt lgkmcnt(5)
    v_pk_fma_f32 v[132:133], v[196:197], v[222:223], v[132:133] op_sel:[0,0,0] op_sel_hi:[1,0,1] neg_lo:[1,0,0] neg_hi:[1,0,0]
    v_pk_fma_f32 v[148:149], v[196:197], v[222:223], v[148:149] op_sel:[0,1,0] op_sel_hi:[1,1,1] neg_lo:[1,0,0] neg_hi:[1,0,0]
    s_waitcnt lgkmcnt(4)
    v_pk_fma_f32 v[132:133], v[132:133], v[244:245], s[44:45]
    v_pk_mul_f32 v[148:149], v[148:149], v[244:245]
    v_pk_add_f32 v[130:131], v[130:131], v[234:235]
    v_cvt_pk_bf16_f32 v161, v130, v131
    v_pk_mul_f32 v[232:233], v[132:133], s[46:47]
    v_max_f32 v132, s44, v132
    v_max_f32 v133, s44, v133
    v_exp_f32 v232, v232 clamp
    v_exp_f32 v233, v233 clamp
    v_cvt_pk_bf16_f32 v170, v148, v149
    s_add_u32 m0, s52, 131072
    s_add_u32 s59, s54, 57344
    buffer_load_dwordx4 v3, s[20:23], s59 offen  lds
    v_pk_fma_f32 v[134:135], v[198:199], v[222:223], v[134:135] op_sel:[0,0,0] op_sel_hi:[1,0,1] neg_lo:[1,0,0] neg_hi:[1,0,0]
    v_pk_fma_f32 v[150:151], v[198:199], v[222:223], v[150:151] op_sel:[0,1,0] op_sel_hi:[1,1,1] neg_lo:[1,0,0] neg_hi:[1,0,0]
    v_pk_fma_f32 v[134:135], v[134:135], v[246:247], s[44:45]
    v_pk_mul_f32 v[150:151], v[150:151], v[246:247]
    v_pk_add_f32 v[132:133], v[132:133], v[232:233]
    v_cvt_pk_bf16_f32 v162, v132, v133
    v_pk_mul_f32 v[234:235], v[134:135], s[46:47]
    v_max_f32 v134, s44, v134
    v_max_f32 v135, s44, v135
    v_exp_f32 v234, v234 clamp
    v_exp_f32 v235, v235 clamp
    v_cvt_pk_bf16_f32 v171, v150, v151
    s_waitcnt lgkmcnt(3)
    v_pk_fma_f32 v[136:137], v[200:201], v[222:223], v[136:137] op_sel:[0,0,0] op_sel_hi:[1,0,1] neg_lo:[1,0,0] neg_hi:[1,0,0]
    v_pk_fma_f32 v[152:153], v[200:201], v[222:223], v[152:153] op_sel:[0,1,0] op_sel_hi:[1,1,1] neg_lo:[1,0,0] neg_hi:[1,0,0]
    s_waitcnt lgkmcnt(2)
    v_pk_fma_f32 v[136:137], v[136:137], v[248:249], s[44:45]
    v_pk_mul_f32 v[152:153], v[152:153], v[248:249]
    v_pk_add_f32 v[134:135], v[134:135], v[234:235]
    v_cvt_pk_bf16_f32 v163, v134, v135
    v_pk_mul_f32 v[232:233], v[136:137], s[46:47]
    v_max_f32 v136, s44, v136
    v_max_f32 v137, s44, v137
    v_exp_f32 v232, v232 clamp
    v_exp_f32 v233, v233 clamp
    v_cvt_pk_bf16_f32 v172, v152, v153
    s_add_u32 m0, s52, 135168
    s_add_u32 s59, s54, 114688
    buffer_load_dwordx4 v3, s[20:23], s59 offen  lds
    v_pk_fma_f32 v[138:139], v[202:203], v[222:223], v[138:139] op_sel:[0,0,0] op_sel_hi:[1,0,1] neg_lo:[1,0,0] neg_hi:[1,0,0]
    v_pk_fma_f32 v[154:155], v[202:203], v[222:223], v[154:155] op_sel:[0,1,0] op_sel_hi:[1,1,1] neg_lo:[1,0,0] neg_hi:[1,0,0]
    v_pk_fma_f32 v[138:139], v[138:139], v[250:251], s[44:45]
    v_pk_mul_f32 v[154:155], v[154:155], v[250:251]
    v_pk_add_f32 v[136:137], v[136:137], v[232:233]
    v_cvt_pk_bf16_f32 v164, v136, v137
    v_pk_mul_f32 v[234:235], v[138:139], s[46:47]
    v_max_f32 v138, s44, v138
    v_max_f32 v139, s44, v139
    v_exp_f32 v234, v234 clamp
    v_exp_f32 v235, v235 clamp
    v_cvt_pk_bf16_f32 v173, v154, v155
    s_waitcnt lgkmcnt(1)
    v_pk_fma_f32 v[140:141], v[204:205], v[222:223], v[140:141] op_sel:[0,0,0] op_sel_hi:[1,0,1] neg_lo:[1,0,0] neg_hi:[1,0,0]
    v_pk_fma_f32 v[156:157], v[204:205], v[222:223], v[156:157] op_sel:[0,1,0] op_sel_hi:[1,1,1] neg_lo:[1,0,0] neg_hi:[1,0,0]
    s_waitcnt lgkmcnt(0)
    v_pk_fma_f32 v[140:141], v[140:141], v[252:253], s[44:45]
    v_pk_mul_f32 v[156:157], v[156:157], v[252:253]
    v_pk_add_f32 v[138:139], v[138:139], v[234:235]
    v_cvt_pk_bf16_f32 v165, v138, v139
    v_pk_mul_f32 v[232:233], v[140:141], s[46:47]
    v_max_f32 v140, s44, v140
    v_max_f32 v141, s44, v141
    v_exp_f32 v232, v232 clamp
    v_exp_f32 v233, v233 clamp
    v_cvt_pk_bf16_f32 v174, v156, v157
    v_pk_fma_f32 v[142:143], v[206:207], v[222:223], v[142:143] op_sel:[0,0,0] op_sel_hi:[1,0,1] neg_lo:[1,0,0] neg_hi:[1,0,0]
    v_pk_fma_f32 v[158:159], v[206:207], v[222:223], v[158:159] op_sel:[0,1,0] op_sel_hi:[1,1,1] neg_lo:[1,0,0] neg_hi:[1,0,0]
    v_pk_fma_f32 v[142:143], v[142:143], v[254:255], s[44:45]
    v_pk_mul_f32 v[158:159], v[158:159], v[254:255]
    v_pk_add_f32 v[140:141], v[140:141], v[232:233]
    v_cvt_pk_bf16_f32 v166, v140, v141
    v_pk_mul_f32 v[234:235], v[142:143], s[46:47]
    v_max_f32 v142, s44, v142
    v_max_f32 v143, s44, v143
    v_exp_f32 v234, v234 clamp
    v_exp_f32 v235, v235 clamp
    v_cvt_pk_bf16_f32 v175, v158, v159
    s_mov_b32 exec_lo, 0xf0000000
    s_mov_b32 exec_hi, 0xf0000000
    v_pk_mov_b32 v[168:169], v[216:217], v[216:217] op_sel:[0,0]
    v_pk_mov_b32 v[170:171], v[216:217], v[216:217] op_sel:[0,0]
    v_pk_mov_b32 v[172:173], v[216:217], v[216:217] op_sel:[0,0]
    v_pk_mov_b32 v[174:175], v[216:217], v[216:217] op_sel:[0,0]
    s_mov_b64 exec, -1
    v_pk_add_f32 v[142:143], v[142:143], v[234:235]
    v_cvt_pk_bf16_f32 v167, v142, v143
    v_mfma_f32_32x32x16_bf16 v[176:191], v[160:163], v[168:171], 0
    s_nop 0
    v_mfma_f32_32x32x16_bf16 v[176:191], v[164:167], v[172:175], v[176:191]
    s_mov_b32 s48, 0x07060302
    s_mov_b32 s49, 0xfffefffe
    v_lshlrev_b32 v239, 3, v1
    v_accvgpr_read_b32 v2, a224
    v_accvgpr_read_b32 v4, a226
    v_accvgpr_read_b32 v5, a227
    v_accvgpr_read_b32 v6, a228
    v_accvgpr_read_b32 v7, a229
    s_nop 3
    ds_write_b128 v13, v[176:179] offset:0
    ds_write_b128 v13, v[180:183] offset:1024
    ds_write_b128 v13, v[184:187] offset:2048
    ds_write_b128 v13, v[188:191] offset:3072
    s_waitcnt lgkmcnt(0)
    s_barrier
    ds_read_b128 v[192:195], v238 offset:0
    ds_read_b128 v[196:199], v238 offset:4096
    ds_read_b128 v[200:203], v238 offset:8192
    ds_read_b128 v[204:207], v238 offset:12288
    s_add_u32 s59, s52, 98304
    v_add_u32_e64 v176, s59, v226
    v_xor_b32 v177, 0x400, v176
    v_xor_b32 v178, 0x800, v176
    v_xor_b32 v179, 0xc00, v176
    s_waitcnt lgkmcnt(2)
    v_pk_add_f32 v[192:193], v[192:193], v[196:197]
    s_waitcnt lgkmcnt(0)
    v_pk_add_f32 v[200:201], v[200:201], v[204:205]
    v_pk_add_f32 v[194:195], v[194:195], v[198:199]
    v_pk_add_f32 v[202:203], v[202:203], v[206:207]
    v_pk_add_f32 v[192:193], v[192:193], v[200:201]
    v_pk_add_f32 v[194:195], v[194:195], v[202:203]
    v_add_u32 v192, 0x10000, v192
    v_add_u32 v193, 0x10000, v193
    v_add_u32 v194, 0x10000, v194
    v_add_u32 v195, 0x10000, v195
    v_perm_b32 v196, v193, v192, s48
    v_perm_b32 v197, v195, v194, s48
    v_and_or_b32 v196, v196, s49, v224
    v_and_or_b32 v197, v197, s49, v225
    buffer_store_dwordx2 v[196:197], v239, s[28:31], s80 offen sc1
    v_mov_b32 v200, v8
    v_mov_b32 v201, v9
    v_accvgpr_read_b32 v8, a230
    v_accvgpr_read_b32 v9, a231
    s_waitcnt vmcnt(4)
    s_barrier
    ds_read_b64_tr_b16 v[160:161], v176 offset:0
    ds_read_b64_tr_b16 v[162:163], v176 offset:256
    ds_read_b64_tr_b16 v[164:165], v176 offset:4096
    ds_read_b64_tr_b16 v[166:167], v176 offset:4352
    ds_read_b64_tr_b16 v[168:169], v176 offset:8192
    ds_read_b64_tr_b16 v[170:171], v176 offset:8448
    s_waitcnt lgkmcnt(4)
    v_mfma_f32_32x32x16_bf16 v[128:143], v[160:163], v[16:19], 0
    v_mfma_f32_16x16x32_bf16 v[208:211], v[228:231], v[160:163], 0
    v_and_b32 v232, 0xffff0000, v220
    s_add_u32 m0, s43, 0
    s_lshl_b32 s63, s6, 7
    s_mul_i32 s62, m0, 7
    s_add_u32 s62, s62, s63
    buffer_load_dwordx4 v2, s[16:19], s62 offen lds
    ds_read_b64_tr_b16 v[172:173], v176 offset:12288
    ds_read_b64_tr_b16 v[174:175], v176 offset:12544
    s_waitcnt lgkmcnt(4)
    v_mfma_f32_32x32x16_bf16 v[128:143], v[164:167], v[32:35], v[128:143]
    v_mfma_f32_16x16x32_bf16 v[208:211], v[228:231], v[164:167], v[208:211]
    s_add_u32 m0, s43, 4096
    s_lshl_b32 s63, s6, 7
    s_mul_i32 s62, m0, 7
    s_add_u32 s62, s62, s63
    buffer_load_dwordx4 v2, s[16:19], s62 offen lds
    ds_read_b64_tr_b16 v[160:161], v176 offset:16384
    ds_read_b64_tr_b16 v[162:163], v176 offset:16640
    s_waitcnt lgkmcnt(4)
    v_mfma_f32_32x32x16_bf16 v[128:143], v[168:171], v[48:51], v[128:143]
    v_mfma_f32_16x16x32_bf16 v[208:211], v[228:231], v[168:171], v[208:211]
    s_add_u32 m0, s52, 65536
    v_sub_f32 v233, v220, v232
    s_add_u32 s59, s54, 172032
    ds_read_b64_tr_b16 v[164:165], v176 offset:20480
    ds_read_b64_tr_b16 v[166:167], v176 offset:20736
    s_waitcnt lgkmcnt(4)
    v_mfma_f32_32x32x16_bf16 v[128:143], v[172:175], v[64:67], v[128:143]
    v_mfma_f32_16x16x32_bf16 v[208:211], v[228:231], v[172:175], v[208:211]
    buffer_load_dwordx4 v3, s[20:23], s59 offen  lds
    v_cvt_pk_bf16_f32 v144, -v232, -v233
    s_add_u32 m0, s52, 69632
    ds_read_b64_tr_b16 v[168:169], v176 offset:24576
    ds_read_b64_tr_b16 v[170:171], v176 offset:24832
    s_waitcnt lgkmcnt(4)
    v_mfma_f32_32x32x16_bf16 v[128:143], v[160:163], v[80:83], v[128:143]
    v_mfma_f32_16x16x32_bf16 v[208:211], v[228:231], v[160:163], v[208:211]
    s_add_u32 s59, s54, 229376
    v_cvt_pk_bf16_f32 v145, -v232, 0
    buffer_load_dwordx4 v3, s[20:23], s59 offen  lds
    ds_read_b64_tr_b16 v[172:173], v177 offset:0
    ds_read_b64_tr_b16 v[174:175], v177 offset:256
    s_waitcnt lgkmcnt(4)
    v_mfma_f32_32x32x16_bf16 v[128:143], v[164:167], v[96:99], v[128:143]
    v_mfma_f32_16x16x32_bf16 v[208:211], v[228:231], v[164:167], v[208:211]
    s_mul_i32 s64, s60, 0x9e3779b1
    s_add_u32 m0, s52, 73728
    v_mov_b32 v146, 0
    ds_read_b64_tr_b16 v[160:161], v178 offset:0
    ds_read_b64_tr_b16 v[162:163], v178 offset:256
    s_waitcnt lgkmcnt(4)
    v_mfma_f32_32x32x16_bf16 v[128:143], v[168:171], v[112:115], v[128:143]
    v_mfma_f32_16x16x32_bf16 v[208:211], v[228:231], v[168:171], v[208:211]
    s_add_u32 s59, s54, 286720
    v_and_b32_e64 v180, 3, v1
    buffer_load_dwordx4 v3, s[20:23], s59 offen  lds
    ds_read_b64_tr_b16 v[164:165], v179 offset:0
    ds_read_b64_tr_b16 v[166:167], v179 offset:256
    s_waitcnt lgkmcnt(4)
    v_mfma_f32_32x32x16_bf16 v[128:143], v[172:175], v[20:23], v[128:143]
    v_mov_b32 v147, 0
    s_add_u32 m0, s52, 77824
    v_lshlrev_b32_e64 v180, 3, v180
    ds_read_b64_tr_b16 v[168:169], v177 offset:4096
    ds_read_b64_tr_b16 v[170:171], v177 offset:4352
    s_waitcnt lgkmcnt(4)
    v_mfma_f32_32x32x16_bf16 v[128:143], v[160:163], v[24:27], v[128:143]
    v_mov_b32 v150, 0
    v_mov_b32_e64 v151, 0
    s_add_u32 s59, s54, 344064
    ds_read_b64_tr_b16 v[172:173], v178 offset:4096
    ds_read_b64_tr_b16 v[174:175], v178 offset:4352
    s_waitcnt lgkmcnt(4)
    v_mfma_f32_32x32x16_bf16 v[128:143], v[164:167], v[28:31], v[128:143]
    v_cndmask_b32 v232, v208, v209, vcc
    ds_write_b32 v200, v232
    buffer_load_dwordx4 v3, s[20:23], s59 offen  lds
    ds_read_b64_tr_b16 v[160:161], v179 offset:4096
    ds_read_b64_tr_b16 v[162:163], v179 offset:4352
    s_waitcnt lgkmcnt(5)
    v_mfma_f32_32x32x16_bf16 v[128:143], v[168:171], v[36:39], v[128:143]
    v_lshrrev_b32 v180, v180, s64
    s_add_u32 s54, s55, 2
    s_and_b32 s54, s54, 3
    ds_read_b64_tr_b16 v[164:165], v177 offset:8192
    ds_read_b64_tr_b16 v[166:167], v177 offset:8448
    s_waitcnt lgkmcnt(5)
    v_mfma_f32_32x32x16_bf16 v[128:143], v[172:175], v[40:43], v[128:143]
    v_and_b32 v180, 0xff, v180
    s_mul_i32 s54, s54, 401408
    v_lshl_or_b32 v180, v180, 15, v180
    ds_read_b64_tr_b16 v[168:169], v178 offset:8192
    ds_read_b64_tr_b16 v[170:171], v178 offset:8448
    s_waitcnt lgkmcnt(4)
    v_mfma_f32_32x32x16_bf16 v[128:143], v[160:163], v[44:47], v[128:143]
    s_add_u32 s54, s54, s53
    s_add_u32 m0, s52, 81920
    v_lshrrev_b32 v181, 2, v180
    ds_read_b64_tr_b16 v[172:173], v179 offset:8192
    ds_read_b64_tr_b16 v[174:175], v179 offset:8448
    s_waitcnt lgkmcnt(4)
    v_mfma_f32_32x32x16_bf16 v[128:143], v[164:167], v[52:55], v[128:143]
    s_barrier
    ds_read_b128 v[212:215], v201
    s_add_u32 s59, s54, 0
    buffer_load_dwordx4 v3, s[20:23], s59 offen  lds
    s_add_u32 m0, s52, 86016
    s_add_u32 s59, s54, 57344
    buffer_load_dwordx4 v3, s[20:23], s59 offen  lds
    s_add_u32 m0, s52, 90112
    s_add_u32 s59, s54, 114688
    buffer_load_dwordx4 v3, s[20:23], s59 offen  lds
    ds_read_b64_tr_b16 v[160:161], v177 offset:12288
    ds_read_b64_tr_b16 v[162:163], v177 offset:12544
    s_waitcnt lgkmcnt(5)
    v_mfma_f32_32x32x16_bf16 v[128:143], v[168:171], v[56:59], v[128:143]
    v_lshrrev_b32 v182, 4, v180
    v_lshrrev_b32 v183, 6, v180
    v_and_b32 v180, 0x10001, v180
    ds_read_b64_tr_b16 v[164:165], v178 offset:12288
    ds_read_b64_tr_b16 v[166:167], v178 offset:12544
    s_waitcnt lgkmcnt(5)
    v_mfma_f32_32x32x16_bf16 v[128:143], v[172:175], v[60:63], v[128:143]
    v_and_b32 v181, 0x10001, v181
    s_add_u32 s62, s4, 0
    s_and_b32 s62, s62, 14
    ds_read_b64_tr_b16 v[168:169], v179 offset:12288
    ds_read_b64_tr_b16 v[170:171], v179 offset:12544
    s_waitcnt lgkmcnt(4)
    v_mfma_f32_32x32x16_bf16 v[128:143], v[160:163], v[68:71], v[128:143]
    v_and_b32 v182, 0x10001, v182
    s_lshl_b32 s62, s62, 11
    s_add_u32 s62, s62, s81
    ds_read_b64_tr_b16 v[172:173], v177 offset:16384
    ds_read_b64_tr_b16 v[174:175], v177 offset:16640
    s_waitcnt lgkmcnt(4)
    v_mfma_f32_32x32x16_bf16 v[128:143], v[164:167], v[72:75], v[128:143]
    v_and_b32 v183, 0x10001, v183
    buffer_load_dwordx4 v[16:19], v7, s[28:31], s62 offen sc1
    s_add_u32 s62, s4, 2
    ds_read_b64_tr_b16 v[160:161], v178 offset:16384
    ds_read_b64_tr_b16 v[162:163], v178 offset:16640
    s_waitcnt lgkmcnt(4)
    v_mfma_f32_32x32x16_bf16 v[128:143], v[168:171], v[76:79], v[128:143]
    s_and_b32 s62, s62, 14
    s_lshr_b32 s64, s3, 1
    s_lshl_b32 s62, s62, 11
    ds_read_b64_tr_b16 v[164:165], v179 offset:16384
    ds_read_b64_tr_b16 v[166:167], v179 offset:16640
    s_waitcnt lgkmcnt(4)
    v_mfma_f32_32x32x16_bf16 v[128:143], v[172:175], v[84:87], v[128:143]
    s_add_u32 s62, s62, s81
    s_lshl_b32 s64, s64, 10
    buffer_load_dwordx4 v[32:35], v7, s[28:31], s62 offen sc1
    ds_read_b64_tr_b16 v[168:169], v177 offset:20480
    ds_read_b64_tr_b16 v[170:171], v177 offset:20736
    s_waitcnt lgkmcnt(4)
    v_mfma_f32_32x32x16_bf16 v[128:143], v[160:163], v[88:91], v[128:143]
    s_add_u32 s62, s4, 4
    v_add_f32 v212, v212, v213
    s_and_b32 s62, s62, 14
    ds_read_b64_tr_b16 v[172:173], v178 offset:20480
    ds_read_b64_tr_b16 v[174:175], v178 offset:20736
    s_waitcnt lgkmcnt(4)
    v_mfma_f32_32x32x16_bf16 v[128:143], v[164:167], v[92:95], v[128:143]
    s_and_b32 s51, s3, 1
    s_lshl_b32 s62, s62, 11
    s_add_u32 s62, s62, s81
    ds_read_b64_tr_b16 v[160:161], v179 offset:20480
    ds_read_b64_tr_b16 v[162:163], v179 offset:20736
    s_waitcnt lgkmcnt(4)
    v_mfma_f32_32x32x16_bf16 v[128:143], v[168:171], v[100:103], v[128:143]
    v_add_f32_e64 v214, v214, v215
    buffer_load_dwordx4 v[48:51], v7, s[28:31], s62 offen sc1
    s_lshl_b32 s51, s51, 3
    ds_read_b64_tr_b16 v[164:165], v177 offset:24576
    ds_read_b64_tr_b16 v[166:167], v177 offset:24832
    s_waitcnt lgkmcnt(4)
    v_mfma_f32_32x32x16_bf16 v[128:143], v[172:175], v[104:107], v[128:143]
    s_add_u32 s62, s4, 6
    s_and_b32 s62, s62, 14
    v_cmp_gt_u32 vcc, 32, v1
    ds_read_b64_tr_b16 v[168:169], v178 offset:24576
    ds_read_b64_tr_b16 v[170:171], v178 offset:24832
    s_waitcnt lgkmcnt(4)
    v_mfma_f32_32x32x16_bf16 v[128:143], v[160:163], v[108:111], v[128:143]
    s_add_u32 s64, s64, s51
    s_add_u32 s64, s64, 161792
    v_lshl_add_u32 v13, v10, 5, s64
    v_lshl_add_u32 v13, v11, 4, v13
    v_add_u32 v202, 161792, v12
    ds_read_b64_tr_b16 v[172:173], v179 offset:24576
    ds_read_b64_tr_b16 v[174:175], v179 offset:24832
    s_waitcnt lgkmcnt(4)
    v_mfma_f32_32x32x16_bf16 v[128:143], v[164:167], v[116:119], v[128:143]
    s_lshl_b32 s62, s62, 11
    s_add_u32 s62, s62, s81
    v_add_f32 v212, v212, v214
    buffer_load_dwordx4 v[64:67], v7, s[28:31], s62 offen sc1
    s_add_u32 s62, s4, 8
    s_waitcnt lgkmcnt(2)
    v_mfma_f32_32x32x16_bf16 v[128:143], v[168:171], v[120:123], v[128:143]
    v_cndmask_b32_e64 v212, 0, v212, vcc
    v_and_b32 v232, 0xffff0000, v212
    v_sub_f32_e64 v233, v212, v232
    v_cvt_pk_bf16_f32 v148, v232, v232
    v_cvt_pk_bf16_f32 v149, v233, 0
    s_waitcnt lgkmcnt(0)
    v_mfma_f32_32x32x16_bf16 v[128:143], v[172:175], v[124:127], v[128:143]
    s_and_b32 s62, s62, 14
    s_lshl_b32 s62, s62, 11
    s_add_u32 s62, s62, s81
    buffer_load_dwordx4 v[80:83], v7, s[28:31], s62 offen sc1
    s_add_u32 s62, s4, 10
    s_and_b32 s62, s62, 14
    v_mfma_f32_32x32x16_bf16 v[128:143], v[148:151], v[144:147], v[128:143]
    s_lshl_b32 s62, s62, 11
    s_add_u32 s62, s62, s81
    buffer_load_dwordx4 v[96:99], v7, s[28:31], s62 offen sc1
    s_add_u32 s62, s4, 12
    s_and_b32 s62, s62, 14
    s_lshl_b32 s62, s62, 11
    s_add_u32 s62, s62, s81
    buffer_load_dwordx4 v[112:115], v7, s[28:31], s62 offen sc1
    s_add_u32 s62, s4, 14
    s_and_b32 s62, s62, 14
    s_lshl_b32 s62, s62, 11
    s_add_u32 s62, s62, s81
    buffer_load_dwordx4 v[20:23], v7, s[28:31], s62 offen sc1
    v_mov_b32 v188, 0x3f80
    v_lshrrev_b32 v187, 1, v10
    v_and_b32 v184, 1, v10
    v_lshlrev_b32 v184, 4, v184
    v_lshlrev_b32 v188, v184, v188
    v_cmp_eq_u32 s[48:49], 0, v187
    v_cmp_eq_u32 s[68:69], 1, v187
    v_cmp_eq_u32 s[62:63], 2, v187
    v_cmp_eq_u32 vcc, 3, v187
    v_cndmask_b32 v184, 0, v188, s[48:49]
    v_cndmask_b32 v185, 0, v188, s[68:69]
    v_cndmask_b32 v186, 0, v188, s[62:63]
    v_cndmask_b32 v187, 0, v188, vcc
    v_pk_fma_f32 v[128:129], v[128:129], v[220:221], s[44:45] op_sel:[0,1,0] op_sel_hi:[1,1,1]
    v_pk_mul_f32 v[232:233], v[128:129], s[46:47]
    v_max_f32 v128, s44, v128
    v_max_f32 v129, s44, v129
    v_exp_f32 v232, v232 clamp
    v_exp_f32 v233, v233 clamp
    v_pk_fma_f32 v[130:131], v[130:131], v[220:221], s[44:45] op_sel:[0,1,0] op_sel_hi:[1,1,1]
    v_pk_add_f32 v[128:129], v[128:129], v[232:233]
    v_cvt_pk_bf16_f32 v240, v128, v129
    v_pk_mul_f32 v[234:235], v[130:131], s[46:47]
    v_max_f32 v130, s44, v130
    v_max_f32 v131, s44, v131
    v_exp_f32 v234, v234 clamp
    v_exp_f32 v235, v235 clamp
    v_pk_fma_f32 v[132:133], v[132:133], v[220:221], s[44:45] op_sel:[0,1,0] op_sel_hi:[1,1,1]
    v_pk_add_f32 v[130:131], v[130:131], v[234:235]
    v_cvt_pk_bf16_f32 v241, v130, v131
    v_pk_mul_f32 v[232:233], v[132:133], s[46:47]
    v_max_f32 v132, s44, v132
    v_max_f32 v133, s44, v133
    v_exp_f32 v232, v232 clamp
    v_exp_f32 v233, v233 clamp
    v_pk_fma_f32 v[134:135], v[134:135], v[220:221], s[44:45] op_sel:[0,1,0] op_sel_hi:[1,1,1]
    v_pk_add_f32 v[132:133], v[132:133], v[232:233]
    v_cvt_pk_bf16_f32 v242, v132, v133
    v_pk_mul_f32 v[234:235], v[134:135], s[46:47]
    v_max_f32 v134, s44, v134
    v_max_f32 v135, s44, v135
    v_exp_f32 v234, v234 clamp
    v_exp_f32 v235, v235 clamp
    v_pk_fma_f32 v[136:137], v[136:137], v[220:221], s[44:45] op_sel:[0,1,0] op_sel_hi:[1,1,1]
    v_pk_add_f32 v[134:135], v[134:135], v[234:235]
    v_cvt_pk_bf16_f32 v243, v134, v135
    v_pk_mul_f32 v[232:233], v[136:137], s[46:47]
    v_max_f32 v136, s44, v136
    v_max_f32 v137, s44, v137
    v_exp_f32 v232, v232 clamp
    v_exp_f32 v233, v233 clamp
    v_pk_fma_f32 v[138:139], v[138:139], v[220:221], s[44:45] op_sel:[0,1,0] op_sel_hi:[1,1,1]
    v_pk_add_f32 v[136:137], v[136:137], v[232:233]
    v_cvt_pk_bf16_f32 v244, v136, v137
    v_pk_mul_f32 v[234:235], v[138:139], s[46:47]
    v_max_f32 v138, s44, v138
    v_max_f32 v139, s44, v139
    v_exp_f32 v234, v234 clamp
    v_exp_f32 v235, v235 clamp
    v_pk_fma_f32 v[140:141], v[140:141], v[220:221], s[44:45] op_sel:[0,1,0] op_sel_hi:[1,1,1]
    v_pk_add_f32 v[138:139], v[138:139], v[234:235]
    v_cvt_pk_bf16_f32 v245, v138, v139
    v_pk_mul_f32 v[232:233], v[140:141], s[46:47]
    v_max_f32 v140, s44, v140
    v_max_f32 v141, s44, v141
    v_exp_f32 v232, v232 clamp
    v_exp_f32 v233, v233 clamp
    v_pk_fma_f32 v[142:143], v[142:143], v[220:221], s[44:45] op_sel:[0,1,0] op_sel_hi:[1,1,1]
    v_pk_add_f32 v[140:141], v[140:141], v[232:233]
    v_cvt_pk_bf16_f32 v246, v140, v141
    v_pk_mul_f32 v[234:235], v[142:143], s[46:47]
    v_max_f32 v142, s44, v142
    v_max_f32 v143, s44, v143
    v_exp_f32 v234, v234 clamp
    v_exp_f32 v235, v235 clamp
    s_nop 0
    v_pk_add_f32 v[142:143], v[142:143], v[234:235]
    v_cvt_pk_bf16_f32 v247, v142, v143
    s_mov_b32 exec_lo, 0
    v_mov_b32_e64 v246, 0
    v_mov_b32 v247, 0
    s_mov_b64 exec, -1
    s_mov_b32 s44, 0x00003f80
    s_mov_b32 s45, 0x3f800000
    s_mov_b32 s64, 0
    s_nop 0
Lh1:
    s_waitcnt vmcnt(7)
    v_xor_b32 v16, v16, v180
    v_xor_b32 v17, v17, v181
    v_xor_b32 v18, v18, v182
    v_xor_b32 v19, v19, v183
    v_or3_b32 v232, v16, v16, v17
    v_or3_b32 v232, v232, v18, v19
    v_mfma_f32_32x32x16_bf16 v[144:159], v[184:187], v[16:19], 0
    s_waitcnt vmcnt(6)
    v_xor_b32 v32, v32, v180
    v_xor_b32 v33, v33, v181
    v_xor_b32 v34, v34, v182
    v_xor_b32_e64 v35, v35, v183
    v_or3_b32 v232, v232, v32, v33
    v_or3_b32 v232, v232, v34, v35
    v_mfma_f32_32x32x16_bf16 v[144:159], v[184:187], v[32:35], v[144:159]
    s_waitcnt vmcnt(5)
    v_xor_b32 v48, v48, v180
    v_xor_b32 v49, v49, v181
    v_xor_b32 v50, v50, v182
    v_xor_b32_e64 v51, v51, v183
    v_or3_b32 v232, v232, v48, v49
    v_or3_b32 v232, v232, v50, v51
    v_mfma_f32_32x32x16_bf16 v[144:159], v[184:187], v[48:51], v[144:159]
    s_waitcnt vmcnt(4)
    v_xor_b32 v64, v64, v180
    v_xor_b32 v65, v65, v181
    v_xor_b32 v66, v66, v182
    v_xor_b32_e64 v67, v67, v183
    v_or3_b32 v232, v232, v64, v65
    v_or3_b32 v232, v232, v66, v67
    v_mfma_f32_32x32x16_bf16 v[144:159], v[184:187], v[64:67], v[144:159]
    s_waitcnt vmcnt(3)
    v_xor_b32 v80, v80, v180
    v_xor_b32 v81, v81, v181
    v_xor_b32 v82, v82, v182
    v_xor_b32_e64 v83, v83, v183
    v_or3_b32 v232, v232, v80, v81
    v_or3_b32 v232, v232, v82, v83
    v_mfma_f32_32x32x16_bf16 v[144:159], v[184:187], v[80:83], v[144:159]
    s_waitcnt vmcnt(2)
    v_xor_b32 v96, v96, v180
    v_xor_b32 v97, v97, v181
    v_xor_b32 v98, v98, v182
    v_xor_b32_e64 v99, v99, v183
    v_or3_b32 v232, v232, v96, v97
    v_or3_b32 v232, v232, v98, v99
    v_mfma_f32_32x32x16_bf16 v[144:159], v[184:187], v[96:99], v[144:159]
    s_waitcnt vmcnt(1)
    v_xor_b32 v112, v112, v180
    v_xor_b32 v113, v113, v181
    v_xor_b32 v114, v114, v182
    v_xor_b32_e64 v115, v115, v183
    v_or3_b32 v232, v232, v112, v113
    v_or3_b32 v232, v232, v114, v115
    v_mfma_f32_32x32x16_bf16 v[144:159], v[184:187], v[112:115], v[144:159]
    s_waitcnt vmcnt(0)
    v_xor_b32 v20, v20, v180
    v_xor_b32 v21, v21, v181
    v_xor_b32 v22, v22, v182
    v_xor_b32_e64 v23, v23, v183
    v_or3_b32 v232, v232, v20, v21
    v_or3_b32 v232, v232, v22, v23
    v_mfma_f32_32x32x16_bf16 v[144:159], v[184:187], v[20:23], v[144:159]
    v_and_b32 v232, 0x10001, v232
    v_cmp_ne_u32 vcc, 0, v232
    s_nop 0
    s_cbranch_vccnz Lh1r
Lh1d:
    s_cmp_eq_u32 s3, 3
    s_cselect_b32 s62, 0xffff, -1
    v_mov_b32 v196, 0
    v_mov_b32 v197, 0
    s_mov_b32 exec_lo, s62
    s_mov_b32 exec_hi, s62
    s_nop 1
    v_cvt_pk_bf16_f32 v196, v144, v145
    v_cvt_pk_bf16_f32 v197, v146, v147
    s_mov_b64 exec, -1
    ds_write_b64 v13, v[196:197]
    s_waitcnt lgkmcnt(0)
    s_barrier
    ds_read_b128 v[204:207], v202
    ds_read_b128 v[208:211], v202 offset:1024
    s_waitcnt lgkmcnt(1)
    v_mfma_f32_32x32x16_bf16 v[144:159], v[204:207], v[240:243], 0
    s_waitcnt lgkmcnt(0)
    v_mfma_f32_32x32x16_bf16 v[144:159], v[208:211], v[244:247], v[144:159]
    s_nop 11
    v_mov_b32 v232, v156
    v_mov_b32_e64 v233, v156
    s_nop 1
    v_permlane32_swap_b32 v233, v232
    v_add_f32 v232, 0x358637bd, v232
    v_rcp_f32 v232, v232
    s_nop 0
    v_pk_mul_f32 v[144:145], v[144:145], v[232:233] op_sel:[0,0] op_sel_hi:[1,0]
    v_pk_mul_f32 v[146:147], v[146:147], v[232:233] op_sel:[0,0] op_sel_hi:[1,0]
    v_pk_mul_f32 v[148:149], v[148:149], v[232:233] op_sel:[0,0] op_sel_hi:[1,0]
    v_pk_mul_f32 v[150:151], v[150:151], v[232:233] op_sel:[0,0] op_sel_hi:[1,0]
    v_pk_mul_f32 v[152:153], v[152:153], v[232:233] op_sel:[0,0] op_sel_hi:[1,0]
    v_pk_mul_f32 v[154:155], v[154:155], v[232:233] op_sel:[0,0] op_sel_hi:[1,0]
    v_pk_mul_f32 v[156:157], v[156:157], v[232:233] op_sel:[0,0] op_sel_hi:[1,0]
    v_pk_mul_f32 v[158:159], v[158:159], v[232:233] op_sel:[0,0] op_sel_hi:[1,0]
    v_cvt_pk_bf16_f32 v192, v144, v145
    v_cvt_pk_bf16_f32 v193, v146, v147
    buffer_store_dwordx2 v[192:193], v239, s[28:31], s78 offen offset:0 sc1
    v_cvt_pk_bf16_f32 v194, v148, v149
    v_cvt_pk_bf16_f32 v195, v150, v151
    buffer_store_dwordx2 v[194:195], v239, s[28:31], s78 offen offset:512 sc1
    v_cvt_pk_bf16_f32 v196, v152, v153
    v_cvt_pk_bf16_f32 v197, v154, v155
    buffer_store_dwordx2 v[196:197], v239, s[28:31], s78 offen offset:1024 sc1
    s_mov_b32 exec_hi, 0
    v_cvt_pk_bf16_f32 v198, v156, v157
    v_cvt_pk_bf16_f32 v199, v158, v159
    buffer_store_dwordx2 v[198:199], v239, s[28:31], s78 offen offset:1536 sc1
    s_mov_b64 exec, -1
    v_and_b32 v9, 0x780, v9
    s_cmp_ge_u32 s5, 14
    s_cbranch_scc1 Lhelp
    s_add_u32 m0, s43, 8192
    s_lshl_b32 s63, s6, 7
    s_mul_i32 s62, m0, 7
    s_add_u32 s62, s62, s63
    buffer_load_dwordx4 v2, s[16:19], s62 offen lds
    s_add_u32 m0, s43, 12288
    s_lshl_b32 s63, s6, 7
    s_mul_i32 s62, m0, 7
    s_add_u32 s62, s62, s63
    buffer_load_dwordx4 v2, s[16:19], s62 offen lds
    s_add_u32 m0, s43, 16384
    s_lshl_b32 s63, s6, 7
    s_mul_i32 s62, m0, 7
    s_add_u32 s62, s62, s63
    buffer_load_dwordx4 v2, s[16:19], s62 offen lds
    s_add_u32 m0, s43, 20480
    s_lshl_b32 s63, s6, 7
    s_mul_i32 s62, m0, 7
    s_add_u32 s62, s62, s63
    buffer_load_dwordx4 v2, s[16:19], s62 offen lds
    s_add_u32 m0, s43, 24576
    s_lshl_b32 s63, s6, 7
    s_mul_i32 s62, m0, 7
    s_add_u32 s62, s62, s63
    buffer_load_dwordx4 v2, s[16:19], s62 offen lds
    s_add_u32 m0, s58, 28672
    s_lshl_b32 s63, s6, 7
    s_mul_i32 s62, m0, 7
    s_add_u32 s62, s62, s63
    buffer_load_dwordx4 v2, s[16:19], s62 offen lds
    s_add_u32 m0, s58, 32768
    s_lshl_b32 s63, s6, 7
    s_mul_i32 s62, m0, 7
    s_add_u32 s62, s62, s63
    buffer_load_dwordx4 v2, s[16:19], s62 offen lds
    s_add_u32 m0, s58, 36864
    s_lshl_b32 s63, s6, 7
    s_mul_i32 s62, m0, 7
    s_add_u32 s62, s62, s63
    buffer_load_dwordx4 v2, s[16:19], s62 offen lds
    v_accvgpr_read_b32 v232, a240
    v_lshlrev_b32_e64 v128, 16, v232
    v_and_b32 v129, 0xffff0000, v232
    v_accvgpr_read_b32 v232, a241
    v_lshlrev_b32_e64 v130, 16, v232
    v_and_b32 v131, 0xffff0000, v232
    v_accvgpr_read_b32 v232, a242
    v_lshlrev_b32_e64 v132, 16, v232
    v_and_b32 v133, 0xffff0000, v232
    v_accvgpr_read_b32 v232, a243
    v_lshlrev_b32_e64 v134, 16, v232
    v_and_b32 v135, 0xffff0000, v232
    v_accvgpr_read_b32 v232, a244
    v_lshlrev_b32_e64 v136, 16, v232
    v_and_b32 v137, 0xffff0000, v232
    v_accvgpr_read_b32 v232, a245
    v_lshlrev_b32_e64 v138, 16, v232
    v_and_b32 v139, 0xffff0000, v232
    v_accvgpr_read_b32 v232, a246
    v_lshlrev_b32_e64 v140, 16, v232
    v_and_b32 v141, 0xffff0000, v232
    v_accvgpr_read_b32 v232, a247
    v_lshlrev_b32 v142, 16, v232
    v_and_b32 v143, 0xffff0000, v232
    s_and_b32 s62, s4, 1
    s_mul_i32 s62, s62, 3
    s_add_u32 s62, s62, s6
    s_and_b32 s63, s2, 3
    s_add_u32 s62, s62, s63
    s_cmp_ge_u32 s62, 7
    s_cselect_b32 s63, 7, 0
    s_sub_u32 s62, s62, s63
    s_lshl_b32 s36, s62, 14
    s_add_u32 s62, s62, 1
    s_cmp_ge_u32 s62, 7
    s_cselect_b32 s63, 7, 0
    s_sub_u32 s62, s62, s63
    s_lshl_b32 s37, s62, 14
    s_add_u32 s62, s62, 1
    s_cmp_ge_u32 s62, 7
    s_cselect_b32 s63, 7, 0
    s_sub_u32 s62, s62, s63
    s_lshl_b32 s38, s62, 14
    s_add_u32 s62, s62, 1
    s_cmp_ge_u32 s62, 7
    s_cselect_b32 s63, 7, 0
    s_sub_u32 s62, s62, s63
    s_lshl_b32 s39, s62, 14
    s_add_u32 s62, s62, 1
    s_cmp_ge_u32 s62, 7
    s_cselect_b32 s63, 7, 0
    s_sub_u32 s62, s62, s63
    s_lshl_b32 s40, s62, 14
    s_add_u32 s62, s62, 1
    s_cmp_ge_u32 s62, 7
    s_cselect_b32 s63, 7, 0
    s_sub_u32 s62, s62, s63
    s_lshl_b32 s41, s62, 14
    s_add_u32 s62, s62, 1
    s_cmp_ge_u32 s62, 7
    s_cselect_b32 s63, 7, 0
    s_sub_u32 s62, s62, s63
    s_lshl_b32 s42, s62, 14
    s_add_u32 s62, s62, 1
    v_accvgpr_read_b32 v191, a239
    s_waitcnt vmcnt(8)
    s_mov_b64 exec, 1
    buffer_store_dword v14, v15, s[28:31], s79 offen
    s_mov_b64 exec, -1
    s_add_u32 m0, s58, 40960
    s_lshl_b32 s63, s6, 7
    s_mul_i32 s62, m0, 7
    s_add_u32 s62, s62, s63
    buffer_load_dwordx4 v2, s[16:19], s62 offen lds
    s_add_u32 m0, s58, 45056
    s_lshl_b32 s63, s6, 7
    s_mul_i32 s62, m0, 7
    s_add_u32 s62, s62, s63
    buffer_load_dwordx4 v2, s[16:19], s62 offen lds
    s_add_u32 m0, s58, 49152
    s_lshl_b32 s63, s6, 7
    s_mul_i32 s62, m0, 7
    s_add_u32 s62, s62, s63
    buffer_load_dwordx4 v2, s[16:19], s62 offen lds
    s_add_u32 m0, s58, 53248
    s_lshl_b32 s63, s6, 7
    s_mul_i32 s62, m0, 7
    s_add_u32 s62, s62, s63
    buffer_load_dwordx4 v2, s[16:19], s62 offen lds
    s_add_u32 m0, s52, 94208
    s_add_u32 s59, s54, 172032
    buffer_load_dwordx4 v3, s[20:23], s59 offen  lds
    s_add_u32 m0, s52, 98304
    s_add_u32 s59, s54, 229376
    buffer_load_dwordx4 v3, s[20:23], s59 offen  lds
    s_add_u32 m0, s52, 102400
    s_add_u32 s59, s54, 286720
    buffer_load_dwordx4 v3, s[20:23], s59 offen  lds
    s_add_u32 m0, s52, 106496
    s_add_u32 s59, s54, 344064
    buffer_load_dwordx4 v3, s[20:23], s59 offen  lds
    s_add_u32 s54, s55, 3
    s_and_b32 s54, s54, 3
    s_mul_i32 s54, s54, 401408
    s_add_u32 s54, s54, s53
    s_add_u32 m0, s52, 110592
    s_add_u32 s59, s54, 0
    buffer_load_dwordx4 v3, s[20:23], s59 offen  lds
    s_add_u32 m0, s52, 114688
    s_add_u32 s59, s54, 57344
    buffer_load_dwordx4 v3, s[20:23], s59 offen  lds
    s_add_u32 m0, s52, 118784
    s_add_u32 s59, s54, 114688
    buffer_load_dwordx4 v3, s[20:23], s59 offen  lds
    s_add_u32 m0, s52, 122880
    s_add_u32 s59, s54, 172032
    buffer_load_dwordx4 v3, s[20:23], s59 offen  lds
    s_add_u32 m0, s52, 139264
    s_add_u32 s59, s54, 229376
    buffer_load_dwordx4 v3, s[20:23], s59 offen  lds
    s_add_u32 m0, s52, 143360
    s_add_u32 s59, s54, 286720
    buffer_load_dwordx4 v3, s[20:23], s59 offen  lds
    s_waitcnt vmcnt(10)
    s_barrier
    ds_read_b64_tr_b16 a[112:113], v8 offset:0
    ds_read_b64_tr_b16 a[114:115], v8 offset:1024
    ds_read_b64_tr_b16 a[116:117], v8 offset:28672
    ds_read_b64_tr_b16 a[118:119], v8 offset:29696
    ds_read_b64_tr_b16 a[120:121], v8 offset:2048
    ds_read_b64_tr_b16 a[122:123], v8 offset:3072
    ds_read_b64_tr_b16 a[124:125], v8 offset:30720
    ds_read_b64_tr_b16 a[126:127], v8 offset:31744
    ds_read_b64_tr_b16 a[128:129], v8 offset:4096
    ds_read_b64_tr_b16 a[130:131], v8 offset:5120
    ds_read_b64_tr_b16 a[132:133], v8 offset:32768
    ds_read_b64_tr_b16 a[134:135], v8 offset:33792
    ds_read_b64_tr_b16 a[136:137], v8 offset:6144
    ds_read_b64_tr_b16 a[138:139], v8 offset:7168
    ds_read_b64_tr_b16 a[140:141], v8 offset:34816
    ds_read_b64_tr_b16 a[142:143], v8 offset:35840
    ds_read_b64_tr_b16 a[144:145], v8 offset:8192
    ds_read_b64_tr_b16 a[146:147], v8 offset:9216
    ds_read_b64_tr_b16 a[148:149], v8 offset:36864
    ds_read_b64_tr_b16 a[150:151], v8 offset:37888
    ds_read_b64_tr_b16 a[152:153], v8 offset:10240
    ds_read_b64_tr_b16 a[154:155], v8 offset:11264
    ds_read_b64_tr_b16 a[156:157], v8 offset:38912
    ds_read_b64_tr_b16 a[158:159], v8 offset:39936
    ds_read_b64_tr_b16 a[160:161], v8 offset:12288
    ds_read_b64_tr_b16 a[162:163], v8 offset:13312
    ds_read_b64_tr_b16 a[164:165], v8 offset:40960
    ds_read_b64_tr_b16 a[166:167], v8 offset:41984
    ds_read_b64_tr_b16 a[168:169], v8 offset:14336
    ds_read_b64_tr_b16 a[170:171], v8 offset:15360
    ds_read_b64_tr_b16 a[172:173], v8 offset:43008
    ds_read_b64_tr_b16 a[174:175], v8 offset:44032
    ds_read_b64_tr_b16 a[176:177], v8 offset:16384
    ds_read_b64_tr_b16 a[178:179], v8 offset:17408
    ds_read_b64_tr_b16 a[180:181], v8 offset:45056
    ds_read_b64_tr_b16 a[182:183], v8 offset:46080
    ds_read_b64_tr_b16 a[184:185], v8 offset:18432
    ds_read_b64_tr_b16 a[186:187], v8 offset:19456
    ds_read_b64_tr_b16 a[188:189], v8 offset:47104
    ds_read_b64_tr_b16 a[190:191], v8 offset:48128
    ds_read_b64_tr_b16 a[192:193], v8 offset:20480
    ds_read_b64_tr_b16 a[194:195], v8 offset:21504
    ds_read_b64_tr_b16 a[196:197], v8 offset:49152
    ds_read_b64_tr_b16 a[198:199], v8 offset:50176
    ds_read_b64_tr_b16 a[200:201], v8 offset:22528
    ds_read_b64_tr_b16 a[202:203], v8 offset:23552
    ds_read_b64_tr_b16 a[204:205], v8 offset:51200
    ds_read_b64_tr_b16 a[206:207], v8 offset:52224
    ds_read_b64_tr_b16 a[208:209], v8 offset:24576
    ds_read_b64_tr_b16 a[210:211], v8 offset:25600
    ds_read_b64_tr_b16 a[212:213], v8 offset:53248
    ds_read_b64_tr_b16 a[214:215], v8 offset:54272
    ds_read_b64_tr_b16 a[216:217], v8 offset:26624
    ds_read_b64_tr_b16 a[218:219], v8 offset:27648
    ds_read_b64_tr_b16 a[220:221], v8 offset:55296
    ds_read_b64_tr_b16 a[222:223], v8 offset:56320
    v_and_b32 v7, 7, v1
    v_lshlrev_b32 v7, 2, v7
    buffer_load_dword v13, v7, s[28:31], s70 offen sc1
    s_waitcnt vmcnt(1) lgkmcnt(0)
    s_barrier
    s_waitcnt vmcnt(0)
    v_cmp_ne_u32 vcc, v13, v14
    s_nop 0
    s_cbranch_vccnz Lsl_2
Lpd_1:
    s_add_u32 m0, s72, 0
    s_add_u32 s62, s71, 0
    buffer_load_dwordx4 v12, s[28:31], s62 offen offset:0 sc1 lds
    buffer_load_dwordx4 v12, s[28:31], s62 offen offset:1024 sc1 lds
    buffer_load_dwordx4 v12, s[28:31], s62 offen offset:2048 sc1 lds
    buffer_load_dwordx4 v12, s[28:31], s62 offen offset:3072 sc1 lds
    s_add_u32 m0, s72, 4096
    s_add_u32 s62, s71, 4096
    buffer_load_dwordx4 v12, s[28:31], s62 offen offset:0 sc1 lds
    buffer_load_dwordx4 v12, s[28:31], s62 offen offset:1024 sc1 lds
    buffer_load_dwordx4 v12, s[28:31], s62 offen offset:2048 sc1 lds
    buffer_load_dwordx4 v12, s[28:31], s62 offen offset:3072 sc1 lds
    s_lshr_b32 s63, s3, 1
    s_lshl_b32 s63, s63, 15
    v_lshl_add_u32 v7, v1, 3, s63
    ds_read_b64_tr_b16 a[28:29], v236 offset:28672
    ds_read_b64_tr_b16 a[30:31], v236 offset:30720
    ds_read_b64_tr_b16 a[32:33], v236 offset:32768
    ds_read_b64_tr_b16 a[34:35], v236 offset:34816
    ds_read_b64_tr_b16 a[36:37], v236 offset:36864
    ds_read_b64_tr_b16 a[38:39], v236 offset:38912
    ds_read_b64_tr_b16 a[40:41], v4 offset:0
    ds_read_b64_tr_b16 a[42:43], v4 offset:2048
    ds_read_b64_tr_b16 a[44:45], v4 offset:4096
    ds_read_b64_tr_b16 a[46:47], v4 offset:6144
    ds_read_b64_tr_b16 a[48:49], v4 offset:8192
    ds_read_b64_tr_b16 a[50:51], v4 offset:10240
    ds_read_b64_tr_b16 a[52:53], v4 offset:12288
    ds_read_b64_tr_b16 a[54:55], v4 offset:14336
    ds_read_b64_tr_b16 a[56:57], v4 offset:16384
    ds_read_b64_tr_b16 a[58:59], v4 offset:18432
    ds_read_b64_tr_b16 a[60:61], v4 offset:20480
    ds_read_b64_tr_b16 a[62:63], v4 offset:22528
    ds_read_b64_tr_b16 a[64:65], v4 offset:24576
    ds_read_b64_tr_b16 a[66:67], v4 offset:26624
    ds_read_b64_tr_b16 a[68:69], v4 offset:28672
    ds_read_b64_tr_b16 a[70:71], v4 offset:30720
    ds_read_b64_tr_b16 a[72:73], v236 offset:0
    ds_read_b64_tr_b16 a[74:75], v236 offset:2048
    ds_read_b64_tr_b16 a[76:77], v236 offset:4096
    ds_read_b64_tr_b16 a[78:79], v236 offset:6144
    ds_read_b64_tr_b16 a[80:81], v236 offset:8192
    ds_read_b64_tr_b16 a[82:83], v236 offset:10240
    ds_read_b64_tr_b16 a[84:85], v236 offset:12288
    ds_read_b64_tr_b16 a[86:87], v236 offset:14336
    ds_read_b64_tr_b16 a[88:89], v236 offset:16384
    ds_read_b64_tr_b16 a[90:91], v236 offset:18432
    ds_read_b64_tr_b16 a[92:93], v236 offset:20480
    ds_read_b64_tr_b16 a[94:95], v236 offset:22528
    ds_read_b64_tr_b16 a[96:97], v236 offset:24576
    ds_read_b64_tr_b16 a[98:99], v236 offset:26624
    ds_read_b64_tr_b16 a[100:101], v236 offset:40960
    ds_read_b64_tr_b16 a[102:103], v236 offset:43008
    ds_read_b64_tr_b16 a[104:105], v236 offset:45056
    ds_read_b64_tr_b16 a[106:107], v236 offset:47104
    s_add_u32 m0, s72, 8192
    s_add_u32 s62, s71, 8192
    buffer_load_dwordx4 v12, s[28:31], s62 offen offset:0 sc1 lds
    buffer_load_dwordx4 v12, s[28:31], s62 offen offset:1024 sc1 lds
    buffer_load_dwordx4 v12, s[28:31], s62 offen offset:2048 sc1 lds
    buffer_load_dwordx4 v12, s[28:31], s62 offen offset:3072 sc1 lds
    s_waitcnt vmcnt(8) lgkmcnt(0)
    s_barrier
    ds_read_b64 v[192:193], v7 offset:0
    ds_read_b64 v[194:195], v7 offset:512
    ds_read_b64 v[196:197], v7 offset:16384
    ds_read_b64 v[198:199], v7 offset:16896
    ds_read_b64 v[200:201], v7 offset:1024
    ds_read_b64 v[202:203], v7 offset:1536
    ds_read_b64 v[204:205], v7 offset:17408
    ds_read_b64 v[206:207], v7 offset:17920
    s_add_u32 m0, s72, 12288
    s_add_u32 s62, s71, 12288
    buffer_load_dwordx4 v12, s[28:31], s62 offen offset:0 sc1 lds
    buffer_load_dwordx4 v12, s[28:31], s62 offen offset:1024 sc1 lds
    ds_read_b64 v[208:209], v7 offset:2048
    ds_read_b64 v[210:211], v7 offset:2560
    s_waitcnt lgkmcnt(8)
    v_mfma_f32_32x32x16_bf16 v[128:143], a[112:115], v[192:195], v[128:143]
    ds_read_b64 v[212:213], v7 offset:18432
    ds_read_b64 v[214:215], v7 offset:18944
    s_waitcnt lgkmcnt(8)
    v_mfma_f32_32x32x16_bf16 v[128:143], a[116:119], v[196:199], v[128:143]
    ds_read_b64 v[192:193], v7 offset:3072
    ds_read_b64 v[194:195], v7 offset:3584
    s_waitcnt lgkmcnt(8)
    v_mfma_f32_32x32x16_bf16 v[128:143], a[120:123], v[200:203], v[128:143]
    s_add_u32 m0, s52, 65536
    s_add_u32 s59, s54, 344064
    ds_read_b64 v[196:197], v7 offset:19456
    ds_read_b64 v[198:199], v7 offset:19968
    s_waitcnt lgkmcnt(8)
    v_mfma_f32_32x32x16_bf16 v[128:143], a[124:127], v[204:207], v[128:143]
    buffer_load_dwordx4 v3, s[20:23], s59 offen  lds
    s_mul_i32 s55, s36, 14
    s_waitcnt vmcnt(7)
    s_barrier
    ds_read_b64 v[200:201], v7 offset:4096
    ds_read_b64 v[202:203], v7 offset:4608
    s_waitcnt lgkmcnt(8)
    v_mfma_f32_32x32x16_bf16 v[128:143], a[128:131], v[208:211], v[128:143]
    s_add_u32 s55, s55, s57
    ds_read_b64 v[204:205], v7 offset:20480
    ds_read_b64 v[206:207], v7 offset:20992
    s_waitcnt lgkmcnt(8)
    v_mfma_f32_32x32x16_bf16 v[128:143], a[132:135], v[212:215], v[128:143]
    s_add_u32 m0, s52, 147456
    s_add_u32 s59, s55, 0
    ds_read_b64 v[208:209], v7 offset:5120
    ds_read_b64 v[210:211], v7 offset:5632
    s_waitcnt lgkmcnt(8)
    v_mfma_f32_32x32x16_bf16 v[128:143], a[136:139], v[192:195], v[128:143]
    buffer_load_dwordx4 v2, s[24:27], s59 offen  lds
    s_add_u32 m0, s52, 151552
    ds_read_b64 v[212:213], v7 offset:21504
    ds_read_b64 v[214:215], v7 offset:22016
    s_waitcnt lgkmcnt(8)
    v_mfma_f32_32x32x16_bf16 v[128:143], a[140:143], v[196:199], v[128:143]
    s_add_u32 s59, s55, 7168
    ds_read_b64 v[192:193], v7 offset:6144
    ds_read_b64 v[194:195], v7 offset:6656
    s_waitcnt lgkmcnt(8)
    v_mfma_f32_32x32x16_bf16 v[128:143], a[144:147], v[200:203], v[128:143]
    buffer_load_dwordx4 v2, s[24:27], s59 offen  lds
    s_add_u32 m0, s52, 155648
    ds_read_b64 v[196:197], v7 offset:22528
    ds_read_b64 v[198:199], v7 offset:23040
    s_waitcnt lgkmcnt(8)
    v_mfma_f32_32x32x16_bf16 v[128:143], a[148:151], v[204:207], v[128:143]
    s_add_u32 s59, s55, 14336
    buffer_load_dwordx4 v2, s[24:27], s59 offen  lds
    ds_read_b64 v[200:201], v7 offset:7168
    ds_read_b64 v[202:203], v7 offset:7680
    s_waitcnt lgkmcnt(8)
    v_mfma_f32_32x32x16_bf16 v[128:143], a[152:155], v[208:211], v[128:143]
    s_add_u32 m0, s52, 159744
    ds_read_b64 v[204:205], v7 offset:23552
    ds_read_b64 v[206:207], v7 offset:24064
    s_waitcnt lgkmcnt(8)
    v_mfma_f32_32x32x16_bf16 v[128:143], a[156:159], v[212:215], v[128:143]
    s_add_u32 s59, s55, 21504
    buffer_load_dwordx4 v2, s[24:27], s59 offen  lds
    s_waitcnt vmcnt(8)
    s_barrier
    ds_read_b64 v[208:209], v7 offset:8192
    ds_read_b64 v[210:211], v7 offset:8704
    s_waitcnt lgkmcnt(8)
    v_mfma_f32_32x32x16_bf16 v[128:143], a[160:163], v[192:195], v[128:143]
    s_mul_i32 s55, s37, 14
    ds_read_b64 v[212:213], v7 offset:24576
    ds_read_b64 v[214:215], v7 offset:25088
    s_waitcnt lgkmcnt(8)
    v_mfma_f32_32x32x16_bf16 v[128:143], a[164:167], v[196:199], v[128:143]
    s_add_u32 s55, s55, s57
    s_add_u32 m0, s52, 126976
    ds_read_b64 v[192:193], v7 offset:9216
    ds_read_b64 v[194:195], v7 offset:9728
    s_waitcnt lgkmcnt(8)
    v_mfma_f32_32x32x16_bf16 v[128:143], a[168:171], v[200:203], v[128:143]
    s_add_u32 s59, s55, 0
    buffer_load_dwordx4 v2, s[24:27], s59 offen  lds
    ds_read_b64 v[196:197], v7 offset:25600
    ds_read_b64 v[198:199], v7 offset:26112
    s_waitcnt lgkmcnt(8)
    v_mfma_f32_32x32x16_bf16 v[128:143], a[172:175], v[204:207], v[128:143]
    s_add_u32 m0, s52, 131072
    ds_read_b64 v[200:201], v7 offset:10240
    ds_read_b64 v[202:203], v7 offset:10752
    s_waitcnt lgkmcnt(8)
    v_mfma_f32_32x32x16_bf16 v[128:143], a[176:179], v[208:211], v[128:143]
    s_add_u32 s59, s55, 7168
    buffer_load_dwordx4 v2, s[24:27], s59 offen  lds
    ds_read_b64 v[204:205], v7 offset:26624
    ds_read_b64 v[206:207], v7 offset:27136
    s_waitcnt lgkmcnt(8)
    v_mfma_f32_32x32x16_bf16 v[128:143], a[180:183], v[212:215], v[128:143]
    s_add_u32 m0, s52, 135168
    s_add_u32 s59, s55, 14336
    s_waitcnt vmcnt(7)
    s_barrier
    ds_read_b64 v[208:209], v7 offset:11264
    ds_read_b64 v[210:211], v7 offset:11776
    s_waitcnt lgkmcnt(8)
    v_mfma_f32_32x32x16_bf16 v[128:143], a[184:187], v[192:195], v[128:143]
    buffer_load_dwordx4 v2, s[24:27], s59 offen  lds
    ds_read_b64 v[212:213], v7 offset:27648
    ds_read_b64 v[214:215], v7 offset:28160
    s_waitcnt lgkmcnt(8)
    v_mfma_f32_32x32x16_bf16 v[128:143], a[188:191], v[196:199], v[128:143]
    s_add_u32 m0, s52, 98304
    s_add_u32 s59, s55, 21504
    ds_read_b64 v[192:193], v7 offset:12288
    ds_read_b64 v[194:195], v7 offset:12800
    s_waitcnt lgkmcnt(8)
    v_mfma_f32_32x32x16_bf16 v[128:143], a[192:195], v[200:203], v[128:143]
    v_mov_b32 v232, 0
    buffer_load_dwordx4 v2, s[24:27], s59 offen  lds
    ds_read_b64 v[196:197], v7 offset:28672
    ds_read_b64 v[198:199], v7 offset:29184
    s_waitcnt lgkmcnt(8)
    v_mfma_f32_32x32x16_bf16 v[128:143], a[196:199], v[204:207], v[128:143]
    v_mov_b32 v233, 0
    s_mul_i32 s55, s38, 14
    ds_read_b64 v[200:201], v7 offset:13312
    ds_read_b64 v[202:203], v7 offset:13824
    s_waitcnt lgkmcnt(8)
    v_mfma_f32_32x32x16_bf16 v[128:143], a[200:203], v[208:211], v[128:143]
    s_add_u32 s55, s55, s57
    v_lshlrev_b32 v13, 3, v10
    ds_read_b64 v[204:205], v7 offset:29696
    ds_read_b64 v[206:207], v7 offset:30208
    s_waitcnt lgkmcnt(8)
    v_mfma_f32_32x32x16_bf16 v[128:143], a[204:207], v[212:215], v[128:143]
    s_add_u32 m0, s52, 102400
    s_add_u32 s59, s55, 0
    buffer_load_dwordx4 v2, s[24:27], s59 offen  lds
    v_lshl_add_u32 v13, v11, 2, v13
    s_waitcnt lgkmcnt(6)
    v_mfma_f32_32x32x16_bf16 v[128:143], a[208:211], v[192:195], v[128:143]
    s_sub_u32 s62, s74, s73
    v_and_b32 v234, 0x80, v9
    v_add_u32_e64 v234, s62, v234
    v_cmp_lt_u32 vcc, 31, v1
    s_waitcnt lgkmcnt(4)
    v_mfma_f32_32x32x16_bf16 v[128:143], a[212:215], v[196:199], v[128:143]
    v_cndmask_b32 v9, v9, v234, vcc
    s_waitcnt lgkmcnt(2)
    v_mfma_f32_32x32x16_bf16 v[128:143], a[216:219], v[200:203], v[128:143]
    s_waitcnt lgkmcnt(0)
    v_mfma_f32_32x32x16_bf16 v[128:143], a[220:223], v[204:207], v[128:143]
    s_nop 11
    v_cvt_pk_bf16_f32 v216, v128, v129
    v_cvt_pk_bf16_f32 v217, v130, v131
    v_cvt_pk_bf16_f32 v218, v132, v133
    v_cvt_pk_bf16_f32 v219, v134, v135
    buffer_store_dwordx4 v[216:219], v12, s[28:31], s73 offen sc1
    v_cvt_pk_bf16_f32 v220, v136, v137
    v_cvt_pk_bf16_f32 v221, v138, v139
    v_cvt_pk_bf16_f32 v222, v140, v141
    v_cvt_pk_bf16_f32 v223, v142, v143
    buffer_store_dwordx4 v[220:223], v12, s[28:31], s73 offen offset:1024 sc1
    v_dot2c_f32_bf16 v232, s61, v216
    v_dot2c_f32_bf16 v233, v216, v216
    v_dot2c_f32_bf16 v232, s61, v217
    v_dot2c_f32_bf16 v233, v217, v217
    v_dot2c_f32_bf16 v232, s61, v218
    v_dot2c_f32_bf16 v233, v218, v218
    v_dot2c_f32_bf16 v232, s61, v219
    v_dot2c_f32_bf16 v233, v219, v219
    v_dot2c_f32_bf16 v232, s61, v220
    v_dot2c_f32_bf16 v233, v220, v220
    v_dot2c_f32_bf16 v232, s61, v221
    v_dot2c_f32_bf16 v233, v221, v221
    v_dot2c_f32_bf16 v232, s61, v222
    v_dot2c_f32_bf16 v233, v222, v222
    v_dot2c_f32_bf16 v232, s61, v223
    v_dot2c_f32_bf16 v233, v223, v223
    s_nop 2
    v_permlane32_swap_b32 v232, v233
    v_add_f32_e64 v232, v232, v233
    buffer_store_dword v232, v13, s[28:31], s74 offen sc1
    s_add_u32 m0, s52, 106496
    s_add_u32 s59, s55, 7168
    buffer_load_dwordx4 v2, s[24:27], s59 offen  lds
    s_add_u32 m0, s52, 110592
    s_add_u32 s59, s55, 14336
    buffer_load_dwordx4 v2, s[24:27], s59 offen  lds
    s_add_u32 m0, s52, 114688
    s_add_u32 s59, s55, 21504
    buffer_load_dwordx4 v2, s[24:27], s59 offen  lds
    s_mul_i32 s55, s39, 14
    s_add_u32 s55, s55, s57
    s_add_u32 m0, s52, 118784
    s_add_u32 s59, s55, 0
    buffer_load_dwordx4 v2, s[24:27], s59 offen  lds
    s_add_u32 m0, s52, 122880
    s_add_u32 s59, s55, 7168
    buffer_load_dwordx4 v2, s[24:27], s59 offen  lds
    s_add_u32 m0, s52, 139264
    s_add_u32 s59, s55, 14336
    buffer_load_dwordx4 v2, s[24:27], s59 offen  lds
    v_pk_mov_b32 v[240:241], v[128:129], v[128:129] op_sel:[0,1]
    v_pk_mov_b32 v[242:243], v[130:131], v[130:131] op_sel:[0,1]
    v_pk_mov_b32 v[244:245], v[132:133], v[132:133] op_sel:[0,1]
    v_pk_mov_b32 v[246:247], v[134:135], v[134:135] op_sel:[0,1]
    v_pk_mov_b32 v[248:249], v[136:137], v[136:137] op_sel:[0,1]
    v_pk_mov_b32 v[250:251], v[138:139], v[138:139] op_sel:[0,1]
    v_pk_mov_b32 v[252:253], v[140:141], v[140:141] op_sel:[0,1]
    v_pk_mov_b32 v[254:255], v[142:143], v[142:143] op_sel:[0,1]
    s_lshl_b32 s63, s4, 2
    s_mul_i32 s68, s3, 7168
    s_mul_i32 s65, s63, 28672
    s_and_b32 s62, s4, 1
    s_lshl_b32 s62, s62, 1
    s_and_b32 s59, s2, 1
    s_add_u32 s62, s62, s59
    s_add_u32 s62, s62, s3
    s_and_b32 s62, s62, 3
    s_mul_i32 s62, s62, 7168
    s_add_u32 s65, s65, s62
    s_add_u32 s65, s65, 4194304
    s_and_b32 s59, s5, 1
    s_mul_i32 s62, s59, 28672
    s_sub_u32 s47, s65, s62
    s_add_u32 s65, s65, s62
    s_lshl_b32 s62, s5, 2
    s_add_u32 s62, s62, s3
    s_mul_i32 s50, s4, 458752
    s_lshl_b32 s64, s62, 11
    s_add_u32 s50, s50, s64
    s_add_u32 s50, s50, 8388608
    s_mul_i32 s64, s59, 114688
    s_sub_u32 s51, s50, s64
    s_add_u32 s51, s51, 114688
    s_add_u32 s50, s50, s64
    s_lshl_b32 s67, s4, 10
    s_lshl_b32 s62, s3, 6
    s_add_u32 s67, s67, s62
    s_add_u32 s67, s67, 12288
    s_lshl_b32 s62, s59, 5
    s_add_u32 s66, s67, s62
    s_lshr_b32 s62, s5, 1
    s_lshl_b32 s62, s62, 2
    s_add_u32 s66, s66, s62
    s_lshl_b32 s62, s7, 5
    s_sub_u32 s45, s67, s62
    s_add_u32 s45, s45, 288
    s_add_u32 s67, s67, s62
    s_add_u32 s63, s63, s7
    s_mul_i32 s48, s63, 28672
    s_lshl_b32 s62, s6, 7
    s_add_u32 s48, s48, s62
    s_mul_i32 s49, s63, 114688
    s_lshl_b32 s62, s3, 11
    s_add_u32 s49, s49, s62
    s_add_u32 s49, s49, 8388608
    s_lshl_b32 s62, s7, 13
    s_sub_u32 s44, s49, s62
    s_add_u32 s44, s44, 8192
    s_add_u32 s49, s49, s62
    s_waitcnt vmcnt(18)
    s_barrier
    ds_read_b64_tr_b16 a[108:109], v4 offset:0
    ds_read_b64_tr_b16 a[110:111], v4 offset:2048
    s_waitcnt vmcnt(6)
    s_mov_b64 exec, 1
    buffer_store_dword v14, v15, s[28:31], s75 offen
    s_mov_b64 exec, -1
    s_waitcnt lgkmcnt(0)
    s_barrier
    v_mfma_f32_16x16x32_bf16 v[180:183], v[228:231], a[0:3], 0
    ds_read_b64_tr_b16 v[16:17], v5 offset:49152
    ds_read_b64_tr_b16 v[20:21], v6 offset:49152
    s_add_u32 m0, s52, 143360
    s_add_u32 s59, s55, 21504
    buffer_load_dwordx4 v2, s[24:27], s59 offen  lds
    v_mfma_f32_16x16x32_bf16 v[180:183], v[228:231], a[4:7], v[180:183]
    ds_read_b64_tr_b16 v[18:19], v5 offset:53248
    ds_read_b64_tr_b16 v[22:23], v6 offset:53248
    s_mul_i32 s55, s40, 14
    s_add_u32 s55, s55, s57
    s_waitcnt lgkmcnt(2)
    s_add_u32 m0, s52, 147456
    s_add_u32 s59, s55, 0
    buffer_load_dwordx4 v2, s[24:27], s59 offen  lds
    v_mfma_f32_16x16x32_bf16 v[180:183], v[228:231], a[8:11], v[180:183]
    ds_read_b64_tr_b16 v[24:25], v5 offset:57344
    ds_read_b64_tr_b16 v[28:29], v6 offset:57344
    s_waitcnt lgkmcnt(2)
    s_add_u32 m0, s52, 151552
    s_add_u32 s59, s55, 7168
    buffer_load_dwordx4 v2, s[24:27], s59 offen  lds
    v_mfma_f32_16x16x32_bf16 v[180:183], v[228:231], a[12:15], v[180:183]
    ds_read_b64_tr_b16 v[26:27], v5 offset:61440
    ds_read_b64_tr_b16 v[30:31], v6 offset:61440
    s_waitcnt lgkmcnt(2)
    s_add_u32 m0, s52, 155648
    s_add_u32 s59, s55, 14336
    buffer_load_dwordx4 v2, s[24:27], s59 offen  lds
    v_mfma_f32_16x16x32_bf16 v[180:183], v[228:231], a[16:19], v[180:183]
    ds_read_b64_tr_b16 v[32:33], v5 offset:28672
    ds_read_b64_tr_b16 v[36:37], v6 offset:28672
    s_waitcnt lgkmcnt(2)
    s_add_u32 m0, s52, 159744
    s_add_u32 s59, s55, 21504
    buffer_load_dwordx4 v2, s[24:27], s59 offen  lds
    v_mfma_f32_16x16x32_bf16 v[180:183], v[228:231], a[20:23], v[180:183]
    ds_read_b64_tr_b16 v[34:35], v5 offset:32768
    ds_read_b64_tr_b16 v[38:39], v6 offset:32768
    s_mul_i32 s55, s41, 14
    s_add_u32 s55, s55, s57
    s_waitcnt lgkmcnt(2)
    s_add_u32 m0, s52, 126976
    s_add_u32 s59, s55, 0
    buffer_load_dwordx4 v2, s[24:27], s59 offen  lds
    v_mfma_f32_16x16x32_bf16 v[180:183], v[228:231], a[24:27], v[180:183]
    ds_read_b64_tr_b16 v[40:41], v5 offset:36864
    ds_read_b64_tr_b16 v[44:45], v6 offset:36864
    s_waitcnt lgkmcnt(2)
    s_add_u32 m0, s52, 131072
    s_add_u32 s59, s55, 7168
    buffer_load_dwordx4 v2, s[24:27], s59 offen  lds
    v_mfma_f32_16x16x32_bf16 v[180:183], v[228:231], a[28:31], v[180:183]
    ds_read_b64_tr_b16 v[42:43], v5 offset:0
    ds_read_b64_tr_b16 v[46:47], v6 offset:0
    s_waitcnt lgkmcnt(2)
    s_add_u32 m0, s52, 135168
    s_add_u32 s59, s55, 14336
    buffer_load_dwordx4 v2, s[24:27], s59 offen  lds
    v_mfma_f32_16x16x32_bf16 v[180:183], v[228:231], a[32:35], v[180:183]
    ds_read_b64_tr_b16 v[48:49], v5 offset:4096
    ds_read_b64_tr_b16 v[52:53], v6 offset:4096
    s_waitcnt lgkmcnt(2)
    s_add_u32 m0, s52, 98304
    s_add_u32 s59, s55, 21504
    buffer_load_dwordx4 v2, s[24:27], s59 offen  lds
    v_mfma_f32_16x16x32_bf16 v[180:183], v[228:231], a[36:39], v[180:183]
    v_mfma_f32_16x16x32_bf16 v[180:183], v[228:231], a[40:43], v[180:183]
    s_waitcnt vmcnt(15)
    ds_read_b64_tr_b16 v[50:51], v5 offset:8192
    ds_read_b64_tr_b16 v[54:55], v6 offset:8192
    s_mul_i32 s55, s42, 14
    s_add_u32 s55, s55, s57
    s_waitcnt lgkmcnt(2)
    s_add_u32 m0, s52, 102400
    s_add_u32 s59, s55, 0
    buffer_load_dwordx4 v2, s[24:27], s59 offen  lds
    v_mfma_f32_16x16x32_bf16 v[180:183], v[228:231], a[44:47], v[180:183]
    s_waitcnt vmcnt(15)
    ds_read_b64_tr_b16 v[56:57], v5 offset:12288
    ds_read_b64_tr_b16 v[60:61], v6 offset:12288
    s_waitcnt lgkmcnt(2)
    s_add_u32 m0, s52, 106496
    s_add_u32 s59, s55, 7168
    buffer_load_dwordx4 v2, s[24:27], s59 offen  lds
    v_mfma_f32_16x16x32_bf16 v[180:183], v[228:231], a[48:51], v[180:183]
    s_waitcnt vmcnt(15)
    ds_read_b64_tr_b16 v[58:59], v5 offset:16384
    ds_read_b64_tr_b16 v[62:63], v6 offset:16384
    s_waitcnt lgkmcnt(2)
    s_add_u32 m0, s52, 110592
    s_add_u32 s59, s55, 14336
    buffer_load_dwordx4 v2, s[24:27], s59 offen  lds
    v_mfma_f32_16x16x32_bf16 v[180:183], v[228:231], a[52:55], v[180:183]
    s_waitcnt vmcnt(15)
    ds_read_b64_tr_b16 v[64:65], v5 offset:20480
    ds_read_b64_tr_b16 v[68:69], v6 offset:20480
    s_waitcnt lgkmcnt(2)
    s_add_u32 m0, s52, 114688
    s_add_u32 s59, s55, 21504
    buffer_load_dwordx4 v2, s[24:27], s59 offen  lds
    v_mfma_f32_16x16x32_bf16 v[180:183], v[228:231], a[56:59], v[180:183]
    s_waitcnt vmcnt(15)
    ds_read_b64_tr_b16 v[66:67], v5 offset:24576
    ds_read_b64_tr_b16 v[70:71], v6 offset:24576
    s_mul_i32 s55, s36, 14
    s_add_u32 s55, s55, s56
    s_waitcnt lgkmcnt(2)
    s_add_u32 m0, s52, 118784
    s_add_u32 s59, s55, 0
    buffer_load_dwordx4 v2, s[24:27], s59 offen  lds
    v_mfma_f32_16x16x32_bf16 v[180:183], v[228:231], a[60:63], v[180:183]
    s_waitcnt vmcnt(15)
    ds_read_b64_tr_b16 v[72:73], v5 offset:40960
    ds_read_b64_tr_b16 v[76:77], v6 offset:40960
    s_waitcnt lgkmcnt(2)
    s_add_u32 m0, s52, 122880
    s_add_u32 s59, s55, 7168
    buffer_load_dwordx4 v2, s[24:27], s59 offen  lds
    v_mfma_f32_16x16x32_bf16 v[180:183], v[228:231], a[64:67], v[180:183]
    s_waitcnt vmcnt(14)
    ds_read_b64_tr_b16 v[74:75], v5 offset:45056
    ds_read_b64_tr_b16 v[78:79], v6 offset:45056
    s_waitcnt lgkmcnt(2)
    s_add_u32 m0, s52, 139264
    s_add_u32 s59, s55, 14336
    buffer_load_dwordx4 v2, s[24:27], s59 offen  lds
    v_mfma_f32_16x16x32_bf16 v[180:183], v[228:231], a[68:71], v[180:183]
    s_waitcnt vmcnt(14)
    ds_read_b64_tr_b16 v[80:81], v5 offset:49152
    ds_read_b64_tr_b16 v[84:85], v6 offset:49152
    s_waitcnt lgkmcnt(2)
    s_add_u32 m0, s52, 143360
    s_add_u32 s59, s55, 21504
    buffer_load_dwordx4 v2, s[24:27], s59 offen  lds
    v_mfma_f32_16x16x32_bf16 v[180:183], v[228:231], a[72:75], v[180:183]
    v_mfma_f32_16x16x32_bf16 v[180:183], v[228:231], a[76:79], v[180:183]
    s_waitcnt vmcnt(14)
    ds_read_b64_tr_b16 v[82:83], v5 offset:53248
    ds_read_b64_tr_b16 v[86:87], v6 offset:53248
    s_mul_i32 s55, s37, 14
    s_add_u32 s55, s55, s56
    s_waitcnt lgkmcnt(2)
    s_add_u32 m0, s52, 147456
    s_add_u32 s59, s55, 0
    buffer_load_dwordx4 v2, s[24:27], s59 offen  lds
    v_mfma_f32_16x16x32_bf16 v[180:183], v[228:231], a[80:83], v[180:183]
    s_waitcnt vmcnt(14)
    ds_read_b64_tr_b16 v[88:89], v5 offset:57344
    ds_read_b64_tr_b16 v[92:93], v6 offset:57344
    s_waitcnt lgkmcnt(2)
    s_add_u32 m0, s52, 151552
    s_add_u32 s59, s55, 7168
    buffer_load_dwordx4 v2, s[24:27], s59 offen  lds
    v_mfma_f32_16x16x32_bf16 v[180:183], v[228:231], a[84:87], v[180:183]
    s_waitcnt vmcnt(14)
    ds_read_b64_tr_b16 v[90:91], v5 offset:61440
    ds_read_b64_tr_b16 v[94:95], v6 offset:61440
    s_waitcnt lgkmcnt(2)
    s_add_u32 m0, s52, 155648
    s_add_u32 s59, s55, 14336
    buffer_load_dwordx4 v2, s[24:27], s59 offen  lds
    v_mfma_f32_16x16x32_bf16 v[180:183], v[228:231], a[88:91], v[180:183]
    s_waitcnt vmcnt(14)
    ds_read_b64_tr_b16 v[96:97], v5 offset:28672
    ds_read_b64_tr_b16 v[100:101], v6 offset:28672
    s_waitcnt lgkmcnt(2)
    s_add_u32 m0, s52, 159744
    s_add_u32 s59, s55, 21504
    buffer_load_dwordx4 v2, s[24:27], s59 offen  lds
    v_mfma_f32_16x16x32_bf16 v[180:183], v[228:231], a[92:95], v[180:183]
    s_waitcnt vmcnt(14)
    ds_read_b64_tr_b16 v[98:99], v5 offset:32768
    ds_read_b64_tr_b16 v[102:103], v6 offset:32768
    s_mul_i32 s55, s38, 14
    s_add_u32 s55, s55, s56
    s_waitcnt lgkmcnt(2)
    s_add_u32 m0, s52, 126976
    s_add_u32 s59, s55, 0
    buffer_load_dwordx4 v2, s[24:27], s59 offen  lds
    v_mfma_f32_16x16x32_bf16 v[180:183], v[228:231], a[96:99], v[180:183]
    s_waitcnt vmcnt(14)
    ds_read_b64_tr_b16 v[104:105], v5 offset:36864
    ds_read_b64_tr_b16 v[108:109], v6 offset:36864
    s_waitcnt lgkmcnt(2)
    s_add_u32 m0, s52, 131072
    s_add_u32 s59, s55, 7168
    buffer_load_dwordx4 v2, s[24:27], s59 offen  lds
    v_mfma_f32_16x16x32_bf16 v[180:183], v[228:231], a[100:103], v[180:183]
    s_waitcnt vmcnt(14)
    ds_read_b64_tr_b16 v[106:107], v5 offset:0
    ds_read_b64_tr_b16 v[110:111], v6 offset:0
    s_waitcnt lgkmcnt(2)
    s_add_u32 m0, s52, 135168
    s_add_u32 s59, s55, 14336
    buffer_load_dwordx4 v2, s[24:27], s59 offen  lds
    v_mfma_f32_16x16x32_bf16 v[180:183], v[228:231], a[104:107], v[180:183]
    s_waitcnt vmcnt(14)
    ds_read_b64_tr_b16 v[112:113], v5 offset:4096
    ds_read_b64_tr_b16 v[116:117], v6 offset:4096
    s_waitcnt lgkmcnt(2)
    s_add_u32 m0, s52, 98304
    s_add_u32 s59, s55, 21504
    buffer_load_dwordx4 v2, s[24:27], s59 offen  lds
    v_mfma_f32_16x16x32_bf16 v[180:183], v[228:231], a[108:111], v[180:183]
    v_and_b32 v7, 15, v1
    v_min_u32 v7, 13, v7
    v_and_b32_e64 v8, 48, v1
    v_add_lshl_u32 v7, v7, v8, 2
    buffer_load_dword v235, v7, s[28:31], s76 offen sc1
    v_and_b32 v13, 16, v1
    v_cmp_ne_u32 vcc, 0, v13
    v_mov_b32 v163, 0
    v_lshlrev_b32 v176, 16, v191
    v_cndmask_b32 v180, v180, v181, vcc
    v_cmp_gt_u32 vcc, 32, v1
    v_lshlrev_b32 v8, 3, v1
    s_nop 0
    v_cndmask_b32 v180, 0, v180, vcc
    v_cndmask_b32 v176, 0, v176, vcc
    v_and_b32 v232, 0xffff0000, v180
    v_sub_f32_e64 v233, v180, v232
    v_cvt_pk_bf16_f32 v160, v232, v232
    v_cvt_pk_bf16_f32 v161, v233, v176
    v_cvt_pk_bf16_f32 v162, v176, 0
    s_add_u32 s62, s52, 114688
    v_and_b32_e64 v13, 15, v1
    v_bfe_u32 v8, v1, 4, 1
    v_lshl_add_u32 v13, v13, 1, v8
    v_lshl_add_u32 v168, v13, 4, s62
    v_lshl_add_u32 v172, v13, 3, s62
    v_lshlrev_b32_e64 v170, 4, v10
    v_add_u32 v170, 114688, v170
    s_and_b32 s62, s5, 1
    s_lshl_b32 s62, s62, 10
    v_subrev_u32 v173, s62, v170
    v_add_u32 v170, s62, v170
    v_mov_b32 v156, 0
    v_mov_b32 v157, 0
    v_mov_b32 v158, 0
    v_mov_b32 v159, 0
    s_lshr_b32 s62, s3, 1
    s_lshl_b32 s62, s62, 1
    s_add_u32 s62, s62, s7
    s_lshl_b32 s62, s62, 10
    s_add_u32 s62, s62, 115200
    v_lshl_add_u32 v169, v10, 3, s62
    s_lshl_b32 s62, s7, 10
    s_add_u32 s62, s62, 115204
    v_and_b32 v171, 0xf8, v0
    v_add_u32 v171, s62, v171
    v_subrev_u32 v3, 98304, v5
    v_xor_b32 v4, 64, v3
    v_add_u32 v9, 57344, v12
    s_waitcnt vmcnt(15)
    ds_read_b64_tr_b16 v[114:115], v5 offset:8192
    ds_read_b64_tr_b16 v[118:119], v6 offset:8192
    s_waitcnt vmcnt(14)
    ds_read_b64_tr_b16 v[120:121], v5 offset:12288
    ds_read_b64_tr_b16 v[124:125], v6 offset:12288
    s_waitcnt vmcnt(13)
    ds_read_b64_tr_b16 v[122:123], v5 offset:16384
    ds_read_b64_tr_b16 v[126:127], v6 offset:16384
    s_waitcnt vmcnt(12)
    ds_read_b64_tr_b16 a[112:113], v5 offset:20480
    ds_read_b64_tr_b16 a[116:117], v6 offset:20480
    s_waitcnt vmcnt(11)
    ds_read_b64_tr_b16 a[114:115], v5 offset:24576
    ds_read_b64_tr_b16 a[118:119], v6 offset:24576
    s_waitcnt vmcnt(10)
    ds_read_b64_tr_b16 a[120:121], v5 offset:40960
    ds_read_b64_tr_b16 a[124:125], v6 offset:40960
    s_waitcnt vmcnt(9)
    ds_read_b64_tr_b16 a[122:123], v5 offset:45056
    ds_read_b64_tr_b16 a[126:127], v6 offset:45056
    s_waitcnt vmcnt(8)
    ds_read_b64_tr_b16 a[128:129], v5 offset:49152
    ds_read_b64_tr_b16 a[132:133], v6 offset:49152
    s_waitcnt vmcnt(7)
    ds_read_b64_tr_b16 a[130:131], v5 offset:53248
    ds_read_b64_tr_b16 a[134:135], v6 offset:53248
    s_waitcnt vmcnt(6)
    ds_read_b64_tr_b16 a[136:137], v5 offset:57344
    ds_read_b64_tr_b16 a[140:141], v6 offset:57344
    s_waitcnt vmcnt(5)
    ds_read_b64_tr_b16 a[138:139], v5 offset:61440
    ds_read_b64_tr_b16 a[142:143], v6 offset:61440
    s_waitcnt vmcnt(4)
    ds_read_b64_tr_b16 a[144:145], v5 offset:28672
    ds_read_b64_tr_b16 a[148:149], v6 offset:28672
    s_waitcnt vmcnt(3)
    ds_read_b64_tr_b16 a[146:147], v5 offset:32768
    ds_read_b64_tr_b16 a[150:151], v6 offset:32768
    s_waitcnt vmcnt(2)
    ds_read_b64_tr_b16 a[152:153], v5 offset:36864
    ds_read_b64_tr_b16 a[156:157], v6 offset:36864
    s_waitcnt vmcnt(1)
    ds_read_b64_tr_b16 a[154:155], v5 offset:0
    ds_read_b64_tr_b16 a[158:159], v6 offset:0
    s_waitcnt lgkmcnt(0)
    s_barrier
    s_waitcnt vmcnt(0)
    v_cmp_ne_u32 vcc, v235, v14
    s_nop 0
    s_cbranch_vccnz Lsl_5
Lpd_4:
    buffer_load_dwordx4 v[144:147], v12, s[28:31], s77 offen offset:0 sc1
    buffer_load_dwordx4 v[148:151], v12, s[28:31], s77 offen offset:1024 sc1
    buffer_load_dwordx4 v[152:155], v12, s[28:31], s77 offen offset:2048 sc1
    s_mov_b32 exec_hi, 0
    buffer_load_dwordx4 v[156:159], v12, s[28:31], s77 offen offset:3072 sc1
    s_mov_b64 exec, -1
    s_add_u32 m0, s68, 0
    s_add_u32 s69, s65, 0
    buffer_load_dwordx4 v12, s[28:31], s69 offen offset:0 sc1 lds
    buffer_load_dwordx4 v12, s[28:31], s69 offen offset:1024 sc1 lds
    buffer_load_dwordx4 v12, s[28:31], s69 offen offset:2048 sc1 lds
    buffer_load_dwordx4 v12, s[28:31], s69 offen offset:3072 sc1 lds
    s_add_u32 m0, s68, 4096
    s_add_u32 s69, s65, 4096
    buffer_load_dwordx4 v12, s[28:31], s69 offen offset:0 sc1 lds
    buffer_load_dwordx4 v12, s[28:31], s69 offen offset:1024 sc1 lds
    buffer_load_dwordx4 v12, s[28:31], s69 offen offset:2048 sc1 lds
    s_add_u32 m0, s68, 28672
    s_add_u32 s69, s47, 28672
    s_waitcnt vmcnt(9)
    v_pk_add_f32 v[144:145], v[144:145], v[148:149]
    v_pk_add_f32 v[146:147], v[146:147], v[150:151]
    s_waitcnt vmcnt(7)
    v_pk_add_f32 v[152:153], v[152:153], v[156:157]
    v_pk_add_f32 v[154:155], v[154:155], v[158:159]
    v_pk_add_f32 v[144:145], v[144:145], v[152:153]
    v_pk_add_f32 v[146:147], v[146:147], v[154:155]
    v_min_u32 v7, 6, v1
    v_lshlrev_b32 v7, 2, v7
    v_permlane16_swap_b32 v144, v146
    v_permlane16_swap_b32 v145, v147
    v_pk_add_f32 v[144:145], v[144:145], v[146:147]
    v_mov_b32 v155, 0
    v_mov_b32 v146, v144
    v_mov_b32 v147, v145
    s_nop 0
    v_permlane32_swap_b32 v144, v146
    v_permlane32_swap_b32 v145, v147
    v_pk_add_f32 v[144:145], v[144:145], v[146:147]
    v_mul_f32 v148, 0x3b124925, v144
    v_mul_f32 v150, 0x3b124925, v145
    v_fma_f32 v150, -v148, v148, v150
    v_and_b32 v144, 0xffff0000, v148
    v_max_f32 v150, 0, v150
    v_sub_f32 v145, v148, v144
    v_add_f32 v150, 0x3727c5ac, v150
    v_cvt_pk_bf16_f32 v152, -v144, -v145
    v_sqrt_f32 v149, v150
    v_rcp_f32 v151, v150
    v_and_b32 v146, 0xffff0000, v149
    v_sub_f32_e64 v147, v149, v146
    v_cvt_pk_bf16_f32 v153, -v144, v146
    v_cvt_pk_bf16_f32 v154, v147, 0
    ds_write_b64 v172, v[150:151] offset:512
    ds_write_b128 v168, v[152:155]
    s_mov_b32 s16, s60
    s_mov_b32 s17, s60
    s_waitcnt vmcnt(0) lgkmcnt(0)
    s_barrier
    ds_read_b128 v[192:195], v12 offset:0
    ds_read_b128 v[196:199], v12 offset:1024
    ds_read_b128 v[200:203], v12 offset:2048
    ds_read_b128 v[204:207], v12 offset:3072
    ds_read_b128 v[208:211], v12 offset:4096
    ds_read_b128 v[212:215], v12 offset:5120
    ds_read_b128 v[216:219], v12 offset:6144
    s_waitcnt lgkmcnt(5)
    v_mfma_f32_32x32x16_bf16 v[128:143], a[0:3], v[192:195], 0
    buffer_load_dwordx4 v12, s[28:31], s69 offen offset:0 sc1 lds
    ds_read_b128 v[220:223], v12 offset:7168
    v_mfma_f32_32x32x16_bf16 v[128:143], a[4:7], v[196:199], v[128:143]
    ds_read_b128 v[176:179], v170 offset:0
    buffer_load_dwordx4 v12, s[28:31], s69 offen offset:1024 sc1 lds
    ds_read_b128 v[180:183], v173 offset:1024
    ds_read_b128 v[192:195], v12 offset:8192
    s_waitcnt lgkmcnt(7)
    v_mfma_f32_32x32x16_bf16 v[128:143], a[8:11], v[200:203], v[128:143]
    buffer_load_dwordx4 v12, s[28:31], s69 offen offset:2048 sc1 lds
    ds_read_b128 v[184:187], v170 offset:2048
    ds_read_b128 v[188:191], v173 offset:3072
    ds_read_b32 v164, v169
    ds_read_b128 v[196:199], v12 offset:9216
    v_mfma_f32_32x32x16_bf16 v[128:143], a[12:15], v[204:207], v[128:143]
    buffer_load_dwordx4 v12, s[28:31], s69 offen offset:3072 sc1 lds
    ds_read_b32 v166, v171
    ds_read_b32 v167, v171 offset:2048
    ds_read_b128 v[200:203], v12 offset:10240
    s_waitcnt lgkmcnt(12)
    v_mfma_f32_32x32x16_bf16 v[128:143], a[16:19], v[208:211], v[128:143]
    s_add_u32 m0, s68, 32768
    ds_read_b128 v[204:207], v12 offset:11264
    v_mfma_f32_32x32x16_bf16 v[128:143], a[20:23], v[212:215], v[128:143]
    ds_read_b128 v[208:211], v12 offset:12288
    s_waitcnt lgkmcnt(12)
    v_mfma_f32_32x32x16_bf16 v[128:143], a[24:27], v[216:219], v[128:143]
    s_add_u32 s69, s47, 32768
    ds_read_b128 v[212:215], v12 offset:13312
    v_mfma_f32_32x32x16_bf16 v[128:143], a[28:31], v[220:223], v[128:143]
    buffer_load_dwordx4 v12, s[28:31], s69 offen offset:0 sc1 lds
    ds_read_b128 v[216:219], v12 offset:14336
    s_waitcnt lgkmcnt(7)
    v_mfma_f32_32x32x16_bf16 v[128:143], a[32:35], v[192:195], v[128:143]
    buffer_load_dwordx4 v12, s[28:31], s69 offen offset:1024 sc1 lds
    ds_read_b128 v[220:223], v12 offset:15360
    v_mfma_f32_32x32x16_bf16 v[128:143], a[36:39], v[196:199], v[128:143]
    buffer_load_dwordx4 v12, s[28:31], s69 offen offset:2048 sc1 lds
    ds_read_b128 v[192:195], v12 offset:16384
    s_waitcnt lgkmcnt(5)
    v_mfma_f32_32x32x16_bf16 v[128:143], a[40:43], v[200:203], v[128:143]
    ds_read_b128 v[196:199], v12 offset:17408
    v_mfma_f32_32x32x16_bf16 v[128:143], a[44:47], v[204:207], v[128:143]
    ds_read_b128 v[200:203], v12 offset:18432
    s_waitcnt lgkmcnt(5)
    v_mfma_f32_32x32x16_bf16 v[128:143], a[48:51], v[208:211], v[128:143]
    s_add_u32 m0, s68, 57344
    v_mul_f32 v240, v240, v164
    v_mul_f32 v241, v241, v164
    v_mul_f32 v242, v242, v164
    ds_read_b128 v[204:207], v12 offset:19456
    v_mfma_f32_32x32x16_bf16 v[128:143], a[52:55], v[212:215], v[128:143]
    s_add_u32 s69, s65, 57344
    v_mul_f32 v243, v243, v164
    v_mul_f32 v244, v244, v164
    ds_read_b128 v[208:211], v12 offset:20480
    s_waitcnt lgkmcnt(5)
    v_mfma_f32_32x32x16_bf16 v[128:143], a[56:59], v[216:219], v[128:143]
    v_mul_f32 v245, v245, v164
    v_mul_f32 v246, v246, v164
    v_mul_f32 v247, v247, v164
    v_mul_f32_e64 v248, v248, v164
    ds_read_b128 v[212:215], v12 offset:21504
    v_mfma_f32_32x32x16_bf16 v[128:143], a[60:63], v[220:223], v[128:143]
    buffer_load_dwordx4 v12, s[28:31], s69 offen offset:0 sc1 lds
    v_mul_f32 v249, v249, v164
    v_mul_f32 v250, v250, v164
    ds_read_b128 v[216:219], v12 offset:22528
    s_waitcnt lgkmcnt(5)
    v_mfma_f32_32x32x16_bf16 v[128:143], a[64:67], v[192:195], v[128:143]
    v_mul_f32 v251, v251, v164
    v_mul_f32 v252, v252, v164
    v_mul_f32 v253, v253, v164
    v_mul_f32_e64 v254, v254, v164
    ds_read_b128 v[220:223], v12 offset:23552
    v_mfma_f32_32x32x16_bf16 v[128:143], a[68:71], v[196:199], v[128:143]
    buffer_load_dwordx4 v12, s[28:31], s69 offen offset:1024 sc1 lds
    v_mul_f32_e64 v255, v255, v164
    ds_read_b128 v[192:195], v12 offset:24576
    s_waitcnt lgkmcnt(5)
    v_mfma_f32_32x32x16_bf16 v[128:143], a[72:75], v[200:203], v[128:143]
    ds_read_b128 v[196:199], v12 offset:25600
    v_mfma_f32_32x32x16_bf16 v[128:143], a[76:79], v[204:207], v[128:143]
    buffer_load_dwordx4 v12, s[28:31], s69 offen offset:2048 sc1 lds
    ds_read_b128 v[200:203], v12 offset:26624
    s_waitcnt lgkmcnt(5)
    v_mfma_f32_32x32x16_bf16 v[128:143], a[80:83], v[208:211], v[128:143]
    ds_read_b128 v[204:207], v12 offset:27648
    v_mfma_f32_32x32x16_bf16 v[128:143], a[84:87], v[212:215], v[128:143]
    buffer_load_dwordx4 v12, s[28:31], s69 offen offset:3072 sc1 lds
    s_waitcnt vmcnt(4)
    s_barrier
    ds_read_b128 v[208:211], v12 offset:28672
    s_waitcnt lgkmcnt(5)
    v_mfma_f32_32x32x16_bf16 v[128:143], a[88:91], v[216:219], v[128:143]
    s_add_u32 m0, s68, 61440
    ds_read_b128 v[212:215], v12 offset:29696
    v_mfma_f32_32x32x16_bf16 v[128:143], a[92:95], v[220:223], v[128:143]
    ds_read_b128 v[216:219], v12 offset:30720
    s_waitcnt lgkmcnt(5)
    v_mfma_f32_32x32x16_bf16 v[128:143], a[96:99], v[192:195], v[128:143]
    s_add_u32 s69, s65, 61440
    ds_read_b128 v[220:223], v12 offset:31744
    v_mfma_f32_32x32x16_bf16 v[128:143], a[100:103], v[196:199], v[128:143]
    ds_read_b128 v[192:195], v12 offset:32768
    s_waitcnt lgkmcnt(5)
    v_mfma_f32_32x32x16_bf16 v[128:143], a[104:107], v[200:203], v[128:143]
    buffer_load_dwordx4 v12, s[28:31], s69 offen offset:0 sc1 lds
    ds_read_b128 v[196:199], v12 offset:33792
    v_mfma_f32_32x32x16_bf16 v[128:143], a[108:111], v[204:207], v[128:143]
    v_mfma_f32_32x32x16_bf16 v[128:143], v[160:163], v[176:179], v[128:143]
    buffer_load_dwordx4 v12, s[28:31], s69 offen offset:1024 sc1 lds
    ds_read_b128 v[200:203], v12 offset:34816
    s_waitcnt lgkmcnt(5)
    v_mfma_f32_32x32x16_bf16 v[144:159], a[0:3], v[208:211], 0
    ds_read_b128 v[204:207], v12 offset:35840
    v_mfma_f32_32x32x16_bf16 v[144:159], a[4:7], v[212:215], v[144:159]
    buffer_load_dwordx4 v12, s[28:31], s69 offen offset:2048 sc1 lds
    ds_read_b128 v[208:211], v12 offset:36864
    s_waitcnt lgkmcnt(5)
    v_mfma_f32_32x32x16_bf16 v[144:159], a[8:11], v[216:219], v[144:159]
    ds_read_b128 v[212:215], v12 offset:37888
    v_mfma_f32_32x32x16_bf16 v[144:159], a[12:15], v[220:223], v[144:159]
    v_mul_f32 v128, v128, |v128|
    v_mul_f32 v129, v129, |v129|
    v_cvt_pk_bf16_f32 v224, v128, v129
    ds_read_b128 v[216:219], v12 offset:38912
    s_waitcnt lgkmcnt(5)
    v_mfma_f32_32x32x16_bf16 v[144:159], a[16:19], v[192:195], v[144:159]
    v_pk_max_i16 v224, v224, 0
    v_mul_f32 v130, v130, |v130|
    v_mul_f32 v131, v131, |v131|
    v_cvt_pk_bf16_f32 v225, v130, v131
    ds_read_b128 v[220:223], v12 offset:39936
    v_mfma_f32_32x32x16_bf16 v[144:159], a[20:23], v[196:199], v[144:159]
    v_pk_max_i16 v225, v225, 0
    v_mul_f32 v132, v132, |v132|
    v_mul_f32 v133, v133, |v133|
    ds_read_b128 v[192:195], v12 offset:40960
    s_waitcnt lgkmcnt(5)
    v_mfma_f32_32x32x16_bf16 v[144:159], a[24:27], v[200:203], v[144:159]
    v_cvt_pk_bf16_f32 v226, v132, v133
    v_pk_max_i16 v226, v226, 0
    v_mul_f32 v134, v134, |v134|
    v_mul_f32 v135, v135, |v135|
    ds_read_b128 v[196:199], v12 offset:41984
    v_mfma_f32_32x32x16_bf16 v[144:159], a[28:31], v[204:207], v[144:159]
    v_cvt_pk_bf16_f32 v227, v134, v135
    v_pk_max_i16 v227, v227, 0
    buffer_store_dwordx4 v[224:227], v12, s[28:31], s50 offen sc1
    ds_read_b128 v[200:203], v12 offset:43008
    s_waitcnt lgkmcnt(5)
    v_mfma_f32_32x32x16_bf16 v[144:159], a[32:35], v[208:211], v[144:159]
    v_mul_f32 v136, v136, |v136|
    v_mul_f32 v137, v137, |v137|
    v_cvt_pk_bf16_f32 v228, v136, v137
    v_pk_max_i16 v228, v228, 0
    ds_read_b128 v[204:207], v12 offset:44032
    v_mfma_f32_32x32x16_bf16 v[144:159], a[36:39], v[212:215], v[144:159]
    v_mul_f32 v138, v138, |v138|
    v_mul_f32 v139, v139, |v139|
    v_cvt_pk_bf16_f32 v229, v138, v139
    ds_read_b128 v[208:211], v12 offset:45056
    s_waitcnt lgkmcnt(5)
    v_mfma_f32_32x32x16_bf16 v[144:159], a[40:43], v[216:219], v[144:159]
    v_pk_max_i16 v229, v229, 0
    v_mul_f32 v140, v140, |v140|
    v_mul_f32 v141, v141, |v141|
    v_cvt_pk_bf16_f32 v230, v140, v141
    ds_read_b128 v[212:215], v12 offset:46080
    v_mfma_f32_32x32x16_bf16 v[144:159], a[44:47], v[220:223], v[144:159]
    v_pk_max_i16 v230, v230, 0
    v_mul_f32 v142, v142, |v142|
    v_mul_f32 v143, v143, |v143|
    ds_read_b128 v[216:219], v12 offset:47104
    s_waitcnt lgkmcnt(5)
    v_mfma_f32_32x32x16_bf16 v[144:159], a[48:51], v[192:195], v[144:159]
    v_cvt_pk_bf16_f32 v231, v142, v143
    v_pk_max_i16 v231, v231, 0
    buffer_store_dwordx4 v[228:231], v12, s[28:31], s50 offen offset:1024 sc1
    s_add_u32 s50, s50, 229376
    ds_read_b128 v[220:223], v12 offset:48128
    v_mfma_f32_32x32x16_bf16 v[144:159], a[52:55], v[196:199], v[144:159]
    s_add_u32 m0, s68, 86016
    s_add_u32 s69, s47, 86016
    buffer_load_dwordx4 v12, s[28:31], s69 offen offset:0 sc1 lds
    ds_read_b128 v[192:195], v12 offset:49152
    s_waitcnt lgkmcnt(5)
    v_mfma_f32_32x32x16_bf16 v[144:159], a[56:59], v[200:203], v[144:159]
    buffer_load_dwordx4 v12, s[28:31], s69 offen offset:1024 sc1 lds
    buffer_load_dwordx4 v12, s[28:31], s69 offen offset:2048 sc1 lds
    buffer_load_dwordx4 v12, s[28:31], s69 offen offset:3072 sc1 lds
    s_add_u32 m0, s68, 90112
    ds_read_b128 v[196:199], v12 offset:50176
    v_mfma_f32_32x32x16_bf16 v[144:159], a[60:63], v[204:207], v[144:159]
    s_add_u32 s69, s47, 90112
    ds_read_b128 v[200:203], v12 offset:51200
    s_waitcnt lgkmcnt(5)
    v_mfma_f32_32x32x16_bf16 v[144:159], a[64:67], v[208:211], v[144:159]
    ds_read_b128 v[204:207], v12 offset:52224
    v_mfma_f32_32x32x16_bf16 v[144:159], a[68:71], v[212:215], v[144:159]
    buffer_load_dwordx4 v12, s[28:31], s69 offen offset:0 sc1 lds
    ds_read_b128 v[208:211], v12 offset:53248
    s_waitcnt lgkmcnt(5)
    v_mfma_f32_32x32x16_bf16 v[144:159], a[72:75], v[216:219], v[144:159]
    ds_read_b128 v[212:215], v12 offset:54272
    v_mfma_f32_32x32x16_bf16 v[144:159], a[76:79], v[220:223], v[144:159]
    buffer_load_dwordx4 v12, s[28:31], s69 offen offset:1024 sc1 lds
    ds_read_b128 v[216:219], v12 offset:55296
    s_waitcnt lgkmcnt(5)
    v_mfma_f32_32x32x16_bf16 v[144:159], a[80:83], v[192:195], v[144:159]
    ds_read_b128 v[220:223], v12 offset:56320
    v_mfma_f32_32x32x16_bf16 v[144:159], a[84:87], v[196:199], v[144:159]
    buffer_load_dwordx4 v12, s[28:31], s69 offen offset:2048 sc1 lds
    s_waitcnt vmcnt(9)
    s_barrier
    ds_read_b128 v[192:195], v9 offset:0
    s_waitcnt lgkmcnt(5)
    v_mfma_f32_32x32x16_bf16 v[144:159], a[88:91], v[200:203], v[144:159]
    ds_read_b128 v[196:199], v9 offset:1024
    v_mfma_f32_32x32x16_bf16 v[144:159], a[92:95], v[204:207], v[144:159]
    s_mul_i32 s55, s39, 14
    s_add_u32 s55, s55, s56
    ds_read_b128 v[200:203], v9 offset:2048
    s_waitcnt lgkmcnt(5)
    v_mfma_f32_32x32x16_bf16 v[144:159], a[96:99], v[208:211], v[144:159]
    s_add_u32 m0, s52, 118784
    ds_read_b128 v[204:207], v9 offset:3072
    v_mfma_f32_32x32x16_bf16 v[144:159], a[100:103], v[212:215], v[144:159]
    s_add_u32 s59, s55, 0
    buffer_load_dwordx4 v2, s[24:27], s59 offen  lds
    ds_read_b128 v[208:211], v9 offset:4096
    s_waitcnt lgkmcnt(5)
    v_mfma_f32_32x32x16_bf16 v[144:159], a[104:107], v[216:219], v[144:159]
    s_add_u32 m0, s52, 122880
    ds_read_b128 v[212:215], v9 offset:5120
    v_mfma_f32_32x32x16_bf16 v[144:159], a[108:111], v[220:223], v[144:159]
    s_add_u32 s59, s55, 7168
    buffer_load_dwordx4 v2, s[24:27], s59 offen  lds
    v_mfma_f32_32x32x16_bf16 v[144:159], v[160:163], v[180:183], v[144:159]
    s_add_u32 m0, s52, 139264
    ds_read_b128 v[216:219], v9 offset:6144
    s_waitcnt lgkmcnt(5)
    v_mfma_f32_32x32x16_bf16 v[128:143], a[0:3], v[192:195], 0
    s_add_u32 s59, s55, 14336
    buffer_load_dwordx4 v2, s[24:27], s59 offen  lds
    ds_read_b128 v[220:223], v9 offset:7168
    v_mfma_f32_32x32x16_bf16 v[128:143], a[4:7], v[196:199], v[128:143]
    s_add_u32 m0, s52, 143360
    ds_read_b128 v[192:195], v9 offset:8192
    s_waitcnt lgkmcnt(5)
    v_mfma_f32_32x32x16_bf16 v[128:143], a[8:11], v[200:203], v[128:143]
    s_add_u32 s59, s55, 21504
    ds_read_b128 v[196:199], v9 offset:9216
    v_mfma_f32_32x32x16_bf16 v[128:143], a[12:15], v[204:207], v[128:143]
    v_mul_f32 v144, v144, |v144|
    v_mul_f32 v145, v145, |v145|
    v_cvt_pk_bf16_f32 v224, v144, v145
    ds_read_b128 v[200:203], v9 offset:10240
    s_waitcnt lgkmcnt(5)
    v_mfma_f32_32x32x16_bf16 v[128:143], a[16:19], v[208:211], v[128:143]
    v_pk_max_i16 v224, v224, 0
    v_mul_f32 v146, v146, |v146|
    v_mul_f32 v147, v147, |v147|
    v_cvt_pk_bf16_f32 v225, v146, v147
    ds_read_b128 v[204:207], v9 offset:11264
    v_mfma_f32_32x32x16_bf16 v[128:143], a[20:23], v[212:215], v[128:143]
    v_pk_max_i16 v225, v225, 0
    v_mul_f32 v148, v148, |v148|
    v_mul_f32 v149, v149, |v149|
    ds_read_b128 v[208:211], v9 offset:12288
    s_waitcnt lgkmcnt(5)
    v_mfma_f32_32x32x16_bf16 v[128:143], a[24:27], v[216:219], v[128:143]
    v_cvt_pk_bf16_f32 v226, v148, v149
    v_pk_max_i16 v226, v226, 0
    v_mul_f32 v150, v150, |v150|
    v_mul_f32 v151, v151, |v151|
    ds_read_b128 v[212:215], v9 offset:13312
    v_mfma_f32_32x32x16_bf16 v[128:143], a[28:31], v[220:223], v[128:143]
    v_cvt_pk_bf16_f32 v227, v150, v151
    v_pk_max_i16 v227, v227, 0
    buffer_store_dwordx4 v[224:227], v12, s[28:31], s51 offen sc1
    ds_read_b128 v[216:219], v9 offset:14336
    s_waitcnt lgkmcnt(5)
    v_mfma_f32_32x32x16_bf16 v[128:143], a[32:35], v[192:195], v[128:143]
    v_mul_f32 v152, v152, |v152|
    v_mul_f32 v153, v153, |v153|
    v_cvt_pk_bf16_f32 v228, v152, v153
    v_pk_max_i16 v228, v228, 0
    ds_read_b128 v[220:223], v9 offset:15360
    v_mfma_f32_32x32x16_bf16 v[128:143], a[36:39], v[196:199], v[128:143]
    v_mul_f32 v154, v154, |v154|
    v_mul_f32 v155, v155, |v155|
    v_cvt_pk_bf16_f32 v229, v154, v155
    ds_read_b128 v[192:195], v9 offset:16384
    s_waitcnt lgkmcnt(5)
    v_mfma_f32_32x32x16_bf16 v[128:143], a[40:43], v[200:203], v[128:143]
    v_pk_max_i16 v229, v229, 0
    v_mul_f32 v156, v156, |v156|
    v_mul_f32 v157, v157, |v157|
    v_cvt_pk_bf16_f32 v230, v156, v157
    ds_read_b128 v[196:199], v9 offset:17408
    v_mfma_f32_32x32x16_bf16 v[128:143], a[44:47], v[204:207], v[128:143]
    s_waitcnt vmcnt(11)
    s_mov_b64 exec, 1
    buffer_store_dword v14, v15, s[28:31], s66 offen
    s_mov_b64 exec, -1
    s_add_u32 s66, s66, 256
    ds_read_b128 v[200:203], v9 offset:18432
    s_waitcnt lgkmcnt(5)
    v_mfma_f32_32x32x16_bf16 v[128:143], a[48:51], v[208:211], v[128:143]
    v_pk_max_i16 v230, v230, 0
    v_mul_f32 v158, v158, |v158|
    v_mul_f32 v159, v159, |v159|
    v_cvt_pk_bf16_f32 v231, v158, v159
    ds_read_b128 v[204:207], v9 offset:19456
    v_mfma_f32_32x32x16_bf16 v[128:143], a[52:55], v[212:215], v[128:143]
    v_pk_max_i16 v231, v231, 0
    buffer_store_dwordx4 v[228:231], v12, s[28:31], s51 offen offset:1024 sc1
    s_add_u32 s51, s51, 229376
    ds_read_b128 v[208:211], v9 offset:20480
    s_waitcnt lgkmcnt(5)
    v_mfma_f32_32x32x16_bf16 v[128:143], a[56:59], v[216:219], v[128:143]
    buffer_load_dwordx4 v2, s[24:27], s59 offen  lds
    s_mul_i32 s55, s40, 14
    s_add_u32 s55, s55, s56
    s_add_u32 m0, s52, 147456
    ds_read_b128 v[212:215], v9 offset:21504
    v_mfma_f32_32x32x16_bf16 v[128:143], a[60:63], v[220:223], v[128:143]
    s_add_u32 s59, s55, 0
    buffer_load_dwordx4 v2, s[24:27], s59 offen  lds
    s_add_u32 m0, s52, 151552
    ds_read_b128 v[216:219], v9 offset:22528
    s_waitcnt lgkmcnt(5)
    v_mfma_f32_32x32x16_bf16 v[128:143], a[64:67], v[192:195], v[128:143]
    s_add_u32 s59, s55, 7168
    buffer_load_dwordx4 v2, s[24:27], s59 offen  lds
    s_add_u32 m0, s52, 155648
    s_add_u32 s59, s55, 14336
    ds_read_b128 v[220:223], v9 offset:23552
    v_mfma_f32_32x32x16_bf16 v[128:143], a[68:71], v[196:199], v[128:143]
    buffer_load_dwordx4 v2, s[24:27], s59 offen  lds
    s_add_u32 m0, s52, 159744
    s_add_u32 s59, s55, 21504
    ds_read_b128 v[192:195], v9 offset:24576
    s_waitcnt lgkmcnt(5)
    v_mfma_f32_32x32x16_bf16 v[128:143], a[72:75], v[200:203], v[128:143]
    buffer_load_dwordx4 v2, s[24:27], s59 offen  lds
    s_mul_i32 s55, s41, 14
    s_add_u32 s55, s55, s56
    s_add_u32 m0, s52, 126976
    ds_read_b128 v[196:199], v9 offset:25600
    v_mfma_f32_32x32x16_bf16 v[128:143], a[76:79], v[204:207], v[128:143]
    s_add_u32 s59, s55, 0
    buffer_load_dwordx4 v2, s[24:27], s59 offen  lds
    s_add_u32 m0, s52, 131072
    ds_read_b128 v[200:203], v9 offset:26624
    s_waitcnt lgkmcnt(5)
    v_mfma_f32_32x32x16_bf16 v[128:143], a[80:83], v[208:211], v[128:143]
    s_add_u32 s59, s55, 7168
    buffer_load_dwordx4 v2, s[24:27], s59 offen  lds
    s_add_u32 m0, s52, 135168
    s_add_u32 s59, s55, 14336
    ds_read_b128 v[204:207], v9 offset:27648
    v_mfma_f32_32x32x16_bf16 v[128:143], a[84:87], v[212:215], v[128:143]
    buffer_load_dwordx4 v2, s[24:27], s59 offen  lds
    s_waitcnt vmcnt(14)
    s_barrier
    ds_read_b128 v[208:211], v9 offset:28672
    s_waitcnt lgkmcnt(5)
    v_mfma_f32_32x32x16_bf16 v[128:143], a[88:91], v[216:219], v[128:143]
    s_add_u32 m0, s52, 114688
    s_add_u32 s59, s55, 21504
    buffer_load_dwordx4 v2, s[24:27], s59 offen  lds
    ds_read_b128 v[212:215], v9 offset:29696
    v_mfma_f32_32x32x16_bf16 v[128:143], a[92:95], v[220:223], v[128:143]
    s_mul_i32 s55, s42, 14
    s_add_u32 s55, s55, s56
    ds_read_b128 v[216:219], v9 offset:30720
    s_waitcnt lgkmcnt(5)
    v_mfma_f32_32x32x16_bf16 v[128:143], a[96:99], v[192:195], v[128:143]
    s_add_u32 m0, s52, 0
    ds_read_b128 v[220:223], v9 offset:31744
    v_mfma_f32_32x32x16_bf16 v[128:143], a[100:103], v[196:199], v[128:143]
    s_add_u32 s59, s55, 0
    ds_read_b128 v[192:195], v9 offset:32768
    s_waitcnt lgkmcnt(5)
    v_mfma_f32_32x32x16_bf16 v[128:143], a[104:107], v[200:203], v[128:143]
    buffer_load_dwordx4 v2, s[24:27], s59 offen  lds
    s_add_u32 m0, s52, 4096
    ds_read_b128 v[196:199], v9 offset:33792
    v_mfma_f32_32x32x16_bf16 v[128:143], a[108:111], v[204:207], v[128:143]
    s_add_u32 s59, s55, 7168
    v_mfma_f32_32x32x16_bf16 v[128:143], v[160:163], v[184:187], v[128:143]
    buffer_load_dwordx4 v2, s[24:27], s59 offen  lds
    s_add_u32 m0, s52, 8192
    ds_read_b128 v[200:203], v9 offset:34816
    s_waitcnt lgkmcnt(5)
    v_mfma_f32_32x32x16_bf16 v[144:159], a[0:3], v[208:211], 0
    s_add_u32 s59, s55, 14336
    ds_read_b128 v[204:207], v9 offset:35840
    v_mfma_f32_32x32x16_bf16 v[144:159], a[4:7], v[212:215], v[144:159]
    buffer_load_dword v13, v7, s[28:31], s67 offen sc1
    buffer_load_dwordx4 v2, s[24:27], s59 offen  lds
    s_add_u32 m0, s52, 12288
    ds_read_b128 v[208:211], v9 offset:36864
    s_waitcnt lgkmcnt(5)
    v_mfma_f32_32x32x16_bf16 v[144:159], a[8:11], v[216:219], v[144:159]
    s_add_u32 s59, s55, 21504
    ds_read_b128 v[212:215], v9 offset:37888
    v_mfma_f32_32x32x16_bf16 v[144:159], a[12:15], v[220:223], v[144:159]
    buffer_load_dwordx4 v2, s[24:27], s59 offen  lds
    v_mul_f32 v128, v128, |v128|
    v_mul_f32 v129, v129, |v129|
    ds_read_b128 v[216:219], v9 offset:38912
    s_waitcnt lgkmcnt(5)
    v_mfma_f32_32x32x16_bf16 v[144:159], a[16:19], v[192:195], v[144:159]
    v_cvt_pk_bf16_f32 v224, v128, v129
    v_pk_max_i16 v224, v224, 0
    v_mul_f32 v130, v130, |v130|
    v_mul_f32 v131, v131, |v131|
    ds_read_b128 v[220:223], v9 offset:39936
    v_mfma_f32_32x32x16_bf16 v[144:159], a[20:23], v[196:199], v[144:159]
    v_cvt_pk_bf16_f32 v225, v130, v131
    v_pk_max_i16 v225, v225, 0
    v_mul_f32 v132, v132, |v132|
    ds_read_b128 v[192:195], v9 offset:40960
    s_waitcnt lgkmcnt(5)
    v_mfma_f32_32x32x16_bf16 v[144:159], a[24:27], v[200:203], v[144:159]
    v_mul_f32 v133, v133, |v133|
    v_cvt_pk_bf16_f32 v226, v132, v133
    v_pk_max_i16 v226, v226, 0
    v_mul_f32 v134, v134, |v134|
    ds_read_b128 v[196:199], v9 offset:41984
    v_mfma_f32_32x32x16_bf16 v[144:159], a[28:31], v[204:207], v[144:159]
    v_mul_f32 v135, v135, |v135|
    v_cvt_pk_bf16_f32 v227, v134, v135
    v_pk_max_i16 v227, v227, 0
    ds_read_b128 v[200:203], v9 offset:43008
    s_waitcnt lgkmcnt(5)
    v_mfma_f32_32x32x16_bf16 v[144:159], a[32:35], v[208:211], v[144:159]
    buffer_store_dwordx4 v[224:227], v12, s[28:31], s50 offen sc1
    v_mul_f32 v136, v136, |v136|
    v_mul_f32 v137, v137, |v137|
    v_cvt_pk_bf16_f32 v228, v136, v137
    ds_read_b128 v[204:207], v9 offset:44032
    v_mfma_f32_32x32x16_bf16 v[144:159], a[36:39], v[212:215], v[144:159]
    v_pk_max_i16 v228, v228, 0
    v_mul_f32 v138, v138, |v138|
    v_mul_f32 v139, v139, |v139|
    ds_read_b128 v[208:211], v9 offset:45056
    s_waitcnt lgkmcnt(5)
    v_mfma_f32_32x32x16_bf16 v[144:159], a[40:43], v[216:219], v[144:159]
    v_cvt_pk_bf16_f32 v229, v138, v139
    v_pk_max_i16 v229, v229, 0
    v_mul_f32 v140, v140, |v140|
    v_mul_f32 v141, v141, |v141|
    ds_read_b128 v[212:215], v9 offset:46080
    v_mfma_f32_32x32x16_bf16 v[144:159], a[44:47], v[220:223], v[144:159]
    s_waitcnt vmcnt(15)
    s_mov_b64 exec, 1
    buffer_store_dword v14, v15, s[28:31], s66 offen
    s_mov_b64 exec, -1
    s_add_u32 s66, s66, 256
    ds_read_b128 v[216:219], v9 offset:47104
    s_waitcnt lgkmcnt(5)
    v_mfma_f32_32x32x16_bf16 v[144:159], a[48:51], v[192:195], v[144:159]
    v_cvt_pk_bf16_f32 v230, v140, v141
    v_pk_max_i16 v230, v230, 0
    v_mul_f32 v142, v142, |v142|
    v_mul_f32 v143, v143, |v143|
    ds_read_b128 v[220:223], v9 offset:48128
    v_mfma_f32_32x32x16_bf16 v[144:159], a[52:55], v[196:199], v[144:159]
    v_cvt_pk_bf16_f32 v231, v142, v143
    v_pk_max_i16 v231, v231, 0
    buffer_store_dwordx4 v[228:231], v12, s[28:31], s50 offen offset:1024 sc1
    s_add_u32 s50, s50, 229376
    ds_read_b128 v[192:195], v9 offset:49152
    s_waitcnt lgkmcnt(5)
    v_mfma_f32_32x32x16_bf16 v[144:159], a[56:59], v[200:203], v[144:159]
    s_waitcnt vmcnt(5)
    v_cmp_ne_u32 vcc, v13, v14
    s_nop 0
    s_cbranch_vccnz Lsl_8
Lpd_7:
    ds_read_b128 v[196:199], v9 offset:50176
    v_mfma_f32_32x32x16_bf16 v[144:159], a[60:63], v[204:207], v[144:159]
    s_add_u32 s67, s67, 512
    s_add_u32 s69, s49, s36
    buffer_load_dwordx4 a[224:227], v12, s[28:31], s69 offen offset:0 sc1
    ds_read_b128 v[200:203], v9 offset:51200
    s_waitcnt lgkmcnt(5)
    v_mfma_f32_32x32x16_bf16 v[144:159], a[64:67], v[208:211], v[144:159]
    buffer_load_dwordx4 a[228:231], v12, s[28:31], s69 offen offset:1024 sc1
    ds_read_b128 v[204:207], v9 offset:52224
    v_mfma_f32_32x32x16_bf16 v[144:159], a[68:71], v[212:215], v[144:159]
    s_add_u32 s69, s49, s37
    ds_read_b128 v[208:211], v9 offset:53248
    s_waitcnt lgkmcnt(5)
    v_mfma_f32_32x32x16_bf16 v[144:159], a[72:75], v[216:219], v[144:159]
    buffer_load_dwordx4 a[232:235], v12, s[28:31], s69 offen offset:0 sc1
    ds_read_b128 v[212:215], v9 offset:54272
    v_mfma_f32_32x32x16_bf16 v[144:159], a[76:79], v[220:223], v[144:159]
    buffer_load_dwordx4 a[236:239], v12, s[28:31], s69 offen offset:1024 sc1
    ds_read_b128 v[216:219], v9 offset:55296
    s_waitcnt lgkmcnt(5)
    v_mfma_f32_32x32x16_bf16 v[144:159], a[80:83], v[192:195], v[144:159]
    s_add_u32 s69, s49, s38
    ds_read_b128 v[220:223], v9 offset:56320
    v_mfma_f32_32x32x16_bf16 v[144:159], a[84:87], v[196:199], v[144:159]
    s_waitcnt lgkmcnt(4)
    v_mfma_f32_32x32x16_bf16 v[144:159], a[88:91], v[200:203], v[144:159]
    buffer_load_dwordx4 a[240:243], v12, s[28:31], s69 offen offset:0 sc1
    v_mfma_f32_32x32x16_bf16 v[144:159], a[92:95], v[204:207], v[144:159]
    buffer_load_dwordx4 a[244:247], v12, s[28:31], s69 offen offset:1024 sc1
    s_waitcnt lgkmcnt(2)
    v_mfma_f32_32x32x16_bf16 v[144:159], a[96:99], v[208:211], v[144:159]
    s_add_u32 s69, s49, s39
    v_mfma_f32_32x32x16_bf16 v[144:159], a[100:103], v[212:215], v[144:159]
    buffer_load_dwordx4 a[252:255], v12, s[28:31], s69 offen offset:0 sc1
    s_waitcnt lgkmcnt(0)
    v_mfma_f32_32x32x16_bf16 v[144:159], a[104:107], v[216:219], v[144:159]
    v_mfma_f32_32x32x16_bf16 v[144:159], a[108:111], v[220:223], v[144:159]
    v_mfma_f32_32x32x16_bf16 v[144:159], v[160:163], v[188:191], v[144:159]
    buffer_load_dwordx4 a[0:3], v12, s[28:31], s69 offen offset:1024 sc1
    s_add_u32 s69, s49, s40
    buffer_load_dwordx4 a[4:7], v12, s[28:31], s69 offen offset:0 sc1
    buffer_load_dwordx4 a[8:11], v12, s[28:31], s69 offen offset:1024 sc1
    s_nop 7
    v_mul_f32 v144, v144, |v144|
    v_mul_f32 v145, v145, |v145|
    v_cvt_pk_bf16_f32 v224, v144, v145
    v_pk_max_i16 v224, v224, 0
    v_mul_f32 v146, v146, |v146|
    v_mul_f32 v147, v147, |v147|
    v_cvt_pk_bf16_f32 v225, v146, v147
    v_pk_max_i16 v225, v225, 0
    v_mul_f32 v148, v148, |v148|
    v_mul_f32 v149, v149, |v149|
    v_cvt_pk_bf16_f32 v226, v148, v149
    v_pk_max_i16 v226, v226, 0
    v_mul_f32 v150, v150, |v150|
    v_mul_f32 v151, v151, |v151|
    v_cvt_pk_bf16_f32 v227, v150, v151
    v_pk_max_i16 v227, v227, 0
    buffer_store_dwordx4 v[224:227], v12, s[28:31], s51 offen sc1
    v_mul_f32 v152, v152, |v152|
    v_mul_f32 v153, v153, |v153|
    v_cvt_pk_bf16_f32 v228, v152, v153
    v_pk_max_i16 v228, v228, 0
    v_mul_f32 v154, v154, |v154|
    v_mul_f32 v155, v155, |v155|
    v_cvt_pk_bf16_f32 v229, v154, v155
    v_pk_max_i16 v229, v229, 0
    v_mul_f32 v156, v156, |v156|
    v_mul_f32 v157, v157, |v157|
    v_cvt_pk_bf16_f32 v230, v156, v157
    v_pk_max_i16 v230, v230, 0
    v_mul_f32 v158, v158, |v158|
    v_mul_f32 v159, v159, |v159|
    v_cvt_pk_bf16_f32 v231, v158, v159
    v_pk_max_i16 v231, v231, 0
    buffer_store_dwordx4 v[228:231], v12, s[28:31], s51 offen offset:1024 sc1
    s_add_u32 s51, s51, 229376
    v_mov_b32 v232, v166
    v_mov_b32 v234, v167
    s_cmp_eq_u32 s3, 0
    s_waitcnt vmcnt(11)
    s_cbranch_scc1 Lia_10
    v_mfma_f32_32x32x16_bf16 v[128:143], v[16:19], a[224:227], 0
    s_branch Lib_11
Lia_10:
    v_mfma_f32_32x32x16_bf16 v[128:143], v[16:19], a[224:227], v[240:255]
Lib_11:
    buffer_load_dword v13, v7, s[28:31], s45 offen sc1
    s_add_u32 s69, s49, s41
    ds_read_b64_tr_b16 a[160:161], v5 offset:20480
    ds_read_b64_tr_b16 a[164:165], v6 offset:20480
    ds_read_b64_tr_b16 a[162:163], v5 offset:24576
    ds_read_b64_tr_b16 a[166:167], v6 offset:24576
    s_cmp_eq_u32 s3, 1
    s_cbranch_scc1 Lia_12
    v_mfma_f32_32x32x16_bf16 v[144:159], v[20:23], a[224:227], 0
    s_branch Lib_13
Lia_12:
    v_mfma_f32_32x32x16_bf16 v[144:159], v[20:23], a[224:227], v[240:255]
Lib_13:
    buffer_load_dwordx4 a[12:15], v12, s[28:31], s69 offen offset:0 sc1
    ds_read_b64_tr_b16 a[168:169], v5 offset:40960
    ds_read_b64_tr_b16 a[172:173], v6 offset:40960
    ds_read_b64_tr_b16 a[170:171], v5 offset:45056
    ds_read_b64_tr_b16 a[174:175], v6 offset:45056
    s_waitcnt vmcnt(12)
    v_mfma_f32_32x32x16_bf16 v[128:143], v[24:27], a[228:231], v[128:143]
    buffer_load_dwordx4 a[16:19], v12, s[28:31], s69 offen offset:1024 sc1
    ds_read_b64_tr_b16 a[176:177], v5 offset:49152
    ds_read_b64_tr_b16 a[180:181], v6 offset:49152
    ds_read_b64_tr_b16 a[178:179], v5 offset:53248
    ds_read_b64_tr_b16 a[182:183], v6 offset:53248
    v_mfma_f32_32x32x16_bf16 v[144:159], v[28:31], a[228:231], v[144:159]
    s_add_u32 s69, s49, s42
    ds_read_b64_tr_b16 a[184:185], v5 offset:57344
    ds_read_b64_tr_b16 a[188:189], v6 offset:57344
    ds_read_b64_tr_b16 a[186:187], v5 offset:61440
    ds_read_b64_tr_b16 a[190:191], v6 offset:61440
    s_waitcnt vmcnt(12)
    v_mfma_f32_32x32x16_bf16 v[128:143], v[32:35], a[232:235], v[128:143]
    buffer_load_dwordx4 a[20:23], v12, s[28:31], s69 offen offset:0 sc1
    s_mov_b64 exec, 1
    buffer_store_dword v14, v15, s[28:31], s66 offen
    s_mov_b64 exec, -1
    s_add_u32 s66, s66, 256
    v_mfma_f32_32x32x16_bf16 v[144:159], v[36:39], a[232:235], v[144:159]
    buffer_load_dwordx4 a[24:27], v12, s[28:31], s69 offen offset:1024 sc1
    ds_read_b64_tr_b16 a[192:193], v5 offset:28672
    ds_read_b64_tr_b16 a[196:197], v6 offset:28672
    ds_read_b64_tr_b16 a[194:195], v5 offset:32768
    ds_read_b64_tr_b16 a[198:199], v6 offset:32768
    s_waitcnt vmcnt(14)
    v_mfma_f32_32x32x16_bf16 v[128:143], v[40:43], a[236:239], v[128:143]
    s_add_u32 s49, s49, 229376
    ds_read_b64_tr_b16 a[200:201], v5 offset:36864
    ds_read_b64_tr_b16 a[204:205], v6 offset:36864
    ds_read_b64_tr_b16 a[202:203], v5 offset:16384
    ds_read_b64_tr_b16 a[206:207], v6 offset:16384
    v_mfma_f32_32x32x16_bf16 v[144:159], v[44:47], a[236:239], v[144:159]
    ds_read_b64_tr_b16 a[208:209], v3 offset:0
    ds_read_b64_tr_b16 a[212:213], v4 offset:0
    ds_read_b64_tr_b16 a[210:211], v3 offset:4096
    ds_read_b64_tr_b16 a[214:215], v4 offset:4096
    s_waitcnt vmcnt(13)
    v_mfma_f32_32x32x16_bf16 v[128:143], v[48:51], a[240:243], v[128:143]
    s_waitcnt vmcnt(5)
    v_cmp_ne_u32 vcc, v13, v14
    s_nop 0
    s_cbranch_vccnz Lsl_15
Lpd_14:
    ds_read_b64_tr_b16 a[216:217], v3 offset:8192
    ds_read_b64_tr_b16 a[220:221], v4 offset:8192
    v_mfma_f32_32x32x16_bf16 v[144:159], v[52:55], a[240:243], v[144:159]
    s_add_u32 s45, s45, 512
    ds_read_b64_tr_b16 a[218:219], v3 offset:12288
    ds_read_b64_tr_b16 a[222:223], v4 offset:12288
    v_mfma_f32_32x32x16_bf16 v[128:143], v[56:59], a[244:247], v[128:143]
    s_add_u32 s69, s44, s36
    v_mfma_f32_32x32x16_bf16 v[144:159], v[60:63], a[244:247], v[144:159]
    buffer_load_dwordx4 a[28:31], v12, s[28:31], s69 offen offset:0 sc1
    v_mfma_f32_32x32x16_bf16 v[128:143], v[64:67], a[252:255], v[128:143]
    buffer_load_dwordx4 a[32:35], v12, s[28:31], s69 offen offset:1024 sc1
    v_mfma_f32_32x32x16_bf16 v[144:159], v[68:71], a[252:255], v[144:159]
    s_add_u32 s69, s44, s37
    v_mfma_f32_32x32x16_bf16 v[128:143], v[72:75], a[0:3], v[128:143]
    buffer_load_dwordx4 a[36:39], v12, s[28:31], s69 offen offset:0 sc1
    v_mfma_f32_32x32x16_bf16 v[144:159], v[76:79], a[0:3], v[144:159]
    buffer_load_dwordx4 a[40:43], v12, s[28:31], s69 offen offset:1024 sc1
    v_mfma_f32_32x32x16_bf16 v[128:143], v[80:83], a[4:7], v[128:143]
    buffer_load_dword v13, v7, s[28:31], s67 offen sc1
    s_add_u32 s69, s44, s38
    v_mfma_f32_32x32x16_bf16 v[144:159], v[84:87], a[4:7], v[144:159]
    buffer_load_dwordx4 a[44:47], v12, s[28:31], s69 offen offset:0 sc1
    v_mfma_f32_32x32x16_bf16 v[128:143], v[88:91], a[8:11], v[128:143]
    buffer_load_dwordx4 a[48:51], v12, s[28:31], s69 offen offset:1024 sc1
    v_mfma_f32_32x32x16_bf16 v[144:159], v[92:95], a[8:11], v[144:159]
    s_add_u32 s69, s44, s39
    s_waitcnt vmcnt(11)
    v_mfma_f32_32x32x16_bf16 v[128:143], v[96:99], a[12:15], v[128:143]
    v_mfma_f32_32x32x16_bf16 v[144:159], v[100:103], a[12:15], v[144:159]
    buffer_load_dwordx4 a[52:55], v12, s[28:31], s69 offen offset:0 sc1
    s_waitcnt vmcnt(11)
    v_mfma_f32_32x32x16_bf16 v[128:143], v[104:107], a[16:19], v[128:143]
    buffer_load_dwordx4 a[56:59], v12, s[28:31], s69 offen offset:1024 sc1
    s_mov_b64 exec, 1
    buffer_store_dword v14, v15, s[28:31], s66 offen
    s_mov_b64 exec, -1
    s_add_u32 s66, s66, 256
    v_mfma_f32_32x32x16_bf16 v[144:159], v[108:111], a[16:19], v[144:159]
    s_add_u32 s69, s44, s40
    s_waitcnt vmcnt(12)
    v_mfma_f32_32x32x16_bf16 v[128:143], v[112:115], a[20:23], v[128:143]
    buffer_load_dwordx4 a[60:63], v12, s[28:31], s69 offen offset:0 sc1
    v_mfma_f32_32x32x16_bf16 v[144:159], v[116:119], a[20:23], v[144:159]
    buffer_load_dwordx4 a[64:67], v12, s[28:31], s69 offen offset:1024 sc1
    s_waitcnt vmcnt(12)
    v_mfma_f32_32x32x16_bf16 v[128:143], v[120:123], a[24:27], v[128:143]
    s_add_u32 s69, s44, s41
    v_mfma_f32_32x32x16_bf16 v[144:159], v[124:127], a[24:27], v[144:159]
    buffer_load_dwordx4 a[68:71], v12, s[28:31], s69 offen offset:0 sc1
    s_waitcnt vmcnt(12)
    v_mfma_f32_32x32x16_bf16 v[128:143], a[112:115], a[28:31], v[128:143]
    buffer_load_dwordx4 a[72:75], v12, s[28:31], s69 offen offset:1024 sc1
    v_mfma_f32_32x32x16_bf16 v[144:159], a[116:119], a[28:31], v[144:159]
    s_add_u32 s69, s44, s42
    s_waitcnt vmcnt(12)
    v_mfma_f32_32x32x16_bf16 v[128:143], a[120:123], a[32:35], v[128:143]
    buffer_load_dwordx4 a[76:79], v12, s[28:31], s69 offen offset:0 sc1
    s_mul_i32 s51, s3, 8704
    s_add_u32 s51, s51, 57344
    v_add_u32 v228, s51, v12
    v_and_b32 v230, 7, v0
    v_mfma_f32_32x32x16_bf16 v[144:159], a[124:127], a[32:35], v[144:159]
    buffer_load_dwordx4 a[80:83], v12, s[28:31], s69 offen offset:1024 sc1
    v_mul_u32_u24 v229, 1088, v230
    v_lshrrev_b32 v8, 3, v0
    v_lshl_add_u32 v229, v8, 4, v229
    s_waitcnt vmcnt(13)
    v_mfma_f32_32x32x16_bf16 v[128:143], a[128:131], a[36:39], v[128:143]
    s_add_u32 s44, s44, 229376
    v_add_u32 v229, 57344, v229
    v_mul_u32_u24 v8, 896, v8
    v_lshl_add_u32 v230, v230, 4, v8
    v_mfma_f32_32x32x16_bf16 v[144:159], a[132:135], a[36:39], v[144:159]
    s_waitcnt vmcnt(12)
    v_mfma_f32_32x32x16_bf16 v[128:143], a[136:139], a[40:43], v[128:143]
    s_waitcnt vmcnt(11)
    v_cmp_ne_u32 vcc, v13, v14
    s_nop 0
    s_cbranch_vccnz Lsl_18
Lpd_17:
    v_mfma_f32_32x32x16_bf16 v[144:159], a[140:143], a[40:43], v[144:159]
    s_add_u32 s67, s67, 512
    s_waitcnt vmcnt(10)
    v_mfma_f32_32x32x16_bf16 v[128:143], a[144:147], a[44:47], v[128:143]
    s_add_u32 s69, s49, s36
    v_mfma_f32_32x32x16_bf16 v[144:159], a[148:151], a[44:47], v[144:159]
    buffer_load_dwordx4 a[84:87], v12, s[28:31], s69 offen offset:0 sc1
    s_waitcnt vmcnt(10)
    v_mfma_f32_32x32x16_bf16 v[128:143], a[152:155], a[48:51], v[128:143]
    buffer_load_dwordx4 a[88:91], v12, s[28:31], s69 offen offset:1024 sc1
    v_mfma_f32_32x32x16_bf16 v[144:159], a[156:159], a[48:51], v[144:159]
    s_add_u32 s69, s49, s37
    s_waitcnt vmcnt(10) lgkmcnt(14)
    v_mfma_f32_32x32x16_bf16 v[128:143], a[160:163], a[52:55], v[128:143]
    s_barrier
    buffer_load_dwordx4 a[92:95], v12, s[28:31], s69 offen offset:0 sc1
    v_mfma_f32_32x32x16_bf16 v[144:159], a[164:167], a[52:55], v[144:159]
    buffer_load_dwordx4 a[96:99], v12, s[28:31], s69 offen offset:1024 sc1
    s_waitcnt vmcnt(11)
    v_mfma_f32_32x32x16_bf16 v[128:143], a[168:171], a[56:59], v[128:143]
    buffer_load_dword v13, v7, s[28:31], s45 offen sc1
    s_add_u32 s69, s49, s38
    v_mfma_f32_32x32x16_bf16 v[144:159], a[172:175], a[56:59], v[144:159]
    buffer_load_dwordx4 a[100:103], v12, s[28:31], s69 offen offset:0 sc1
    s_waitcnt vmcnt(11)
    v_mfma_f32_32x32x16_bf16 v[128:143], a[176:179], a[60:63], v[128:143]
    buffer_load_dwordx4 a[104:107], v12, s[28:31], s69 offen offset:1024 sc1
    v_mfma_f32_32x32x16_bf16 v[144:159], a[180:183], a[60:63], v[144:159]
    s_add_u32 s69, s49, s39
    s_waitcnt vmcnt(11)
    v_mfma_f32_32x32x16_bf16 v[128:143], a[184:187], a[64:67], v[128:143]
    v_mfma_f32_32x32x16_bf16 v[144:159], a[188:191], a[64:67], v[144:159]
    buffer_load_dwordx4 a[108:111], v12, s[28:31], s69 offen offset:0 sc1
    s_waitcnt vmcnt(11) lgkmcnt(13)
    v_mfma_f32_32x32x16_bf16 v[128:143], a[192:195], a[68:71], v[128:143]
    buffer_load_dwordx4 a[224:227], v12, s[28:31], s69 offen offset:1024 sc1
    s_waitcnt lgkmcnt(12)
    v_mfma_f32_32x32x16_bf16 v[144:159], a[196:199], a[68:71], v[144:159]
    s_add_u32 s69, s49, s40
    s_waitcnt vmcnt(11) lgkmcnt(9)
    v_mfma_f32_32x32x16_bf16 v[128:143], a[200:203], a[72:75], v[128:143]
    buffer_load_dwordx4 a[228:231], v12, s[28:31], s69 offen offset:0 sc1
    s_waitcnt lgkmcnt(8)
    v_mfma_f32_32x32x16_bf16 v[144:159], a[204:207], a[72:75], v[144:159]
    buffer_load_dwordx4 a[232:235], v12, s[28:31], s69 offen offset:1024 sc1
    s_waitcnt vmcnt(12) lgkmcnt(5)
    v_mfma_f32_32x32x16_bf16 v[128:143], a[208:211], a[76:79], v[128:143]
    s_add_u32 s69, s49, s41
    s_waitcnt lgkmcnt(4)
    v_mfma_f32_32x32x16_bf16 v[144:159], a[212:215], a[76:79], v[144:159]
    buffer_load_dwordx4 a[236:239], v12, s[28:31], s69 offen offset:0 sc1
    s_waitcnt vmcnt(12) lgkmcnt(1)
    v_mfma_f32_32x32x16_bf16 v[128:143], a[216:219], a[80:83], v[128:143]
    buffer_load_dwordx4 a[240:243], v12, s[28:31], s69 offen offset:1024 sc1
    s_waitcnt lgkmcnt(0)
    v_mfma_f32_32x32x16_bf16 v[144:159], a[220:223], a[80:83], v[144:159]
    s_add_u32 s69, s49, s42
    s_cmp_eq_u32 s3, 2
    s_waitcnt vmcnt(12)
    s_cbranch_scc1 Lia_20
    v_mfma_f32_32x32x16_bf16 v[160:175], v[16:19], a[84:87], 0
    s_branch Lib_21
Lia_20:
    v_mfma_f32_32x32x16_bf16 v[160:175], v[16:19], a[84:87], v[240:255]
Lib_21:
    buffer_load_dwordx4 a[244:247], v12, s[28:31], s69 offen offset:0 sc1
    s_cmp_eq_u32 s3, 3
    s_cbranch_scc1 Lia_22
    v_mfma_f32_32x32x16_bf16 v[176:191], v[20:23], a[84:87], 0
    s_branch Lib_23
Lia_22:
    v_mfma_f32_32x32x16_bf16 v[176:191], v[20:23], a[84:87], v[240:255]
Lib_23:
    buffer_load_dwordx4 a[252:255], v12, s[28:31], s69 offen offset:1024 sc1
    s_waitcnt vmcnt(13)
    v_mfma_f32_32x32x16_bf16 v[160:175], v[24:27], a[88:91], v[160:175]
    s_add_u32 s49, s49, 229376
    v_mfma_f32_32x32x16_bf16 v[176:191], v[28:31], a[88:91], v[176:191]
    s_waitcnt vmcnt(12)
    v_mfma_f32_32x32x16_bf16 v[160:175], v[32:35], a[92:95], v[160:175]
    s_waitcnt vmcnt(10)
    v_cmp_ne_u32 vcc, v13, v14
    s_nop 0
    s_cbranch_vccnz Lsl_25
Lpd_24:
    v_mfma_f32_32x32x16_bf16 v[176:191], v[36:39], a[92:95], v[176:191]
    s_add_u32 s45, s45, 512
    ds_write_b128 v228, v[128:131] offset:0
    v_mfma_f32_32x32x16_bf16 v[160:175], v[40:43], a[96:99], v[160:175]
    s_add_u32 s69, s44, s36
    v_accvgpr_read_b32 v241, a248
    ds_write_b128 v228, v[132:135] offset:1088
    v_lshlrev_b32 v240, 16, v241
    v_and_b32 v241, 0xffff0000, v241
    v_mfma_f32_32x32x16_bf16 v[176:191], v[44:47], a[96:99], v[176:191]
    buffer_load_dwordx4 a[0:3], v12, s[28:31], s69 offen offset:0 sc1
    v_accvgpr_read_b32 v243, a249
    v_lshlrev_b32 v242, 16, v243
    v_and_b32 v243, 0xffff0000, v243
    s_waitcnt vmcnt(10)
    v_mfma_f32_32x32x16_bf16 v[160:175], v[48:51], a[100:103], v[160:175]
    buffer_load_dwordx4 a[4:7], v12, s[28:31], s69 offen offset:1024 sc1
    ds_write_b128 v228, v[136:139] offset:2176
    v_accvgpr_read_b32 v245, a250
    v_lshlrev_b32_e64 v244, 16, v245
    v_and_b32 v245, 0xffff0000, v245
    v_mfma_f32_32x32x16_bf16 v[176:191], v[52:55], a[100:103], v[176:191]
    v_accvgpr_read_b32 v247, a251
    v_lshlrev_b32 v246, 16, v247
    v_and_b32 v247, 0xffff0000, v247
    s_waitcnt vmcnt(10)
    v_mfma_f32_32x32x16_bf16 v[160:175], v[56:59], a[104:107], v[160:175]
    s_add_u32 s69, s44, s37
    ds_write_b128 v228, v[140:143] offset:3264
    v_mfma_f32_32x32x16_bf16 v[176:191], v[60:63], a[104:107], v[176:191]
    buffer_load_dwordx4 a[8:11], v12, s[28:31], s69 offen offset:0 sc1
    s_waitcnt vmcnt(10)
    v_mfma_f32_32x32x16_bf16 v[160:175], v[64:67], a[108:111], v[160:175]
    buffer_load_dwordx4 a[12:15], v12, s[28:31], s69 offen offset:1024 sc1
    ds_write_b128 v228, v[144:147] offset:4352
    v_mfma_f32_32x32x16_bf16 v[176:191], v[68:71], a[108:111], v[176:191]
    s_add_u32 s69, s44, s38
    ds_write_b128 v228, v[148:151] offset:5440
    s_waitcnt vmcnt(10)
    v_mfma_f32_32x32x16_bf16 v[160:175], v[72:75], a[224:227], v[160:175]
    buffer_load_dwordx4 a[16:19], v12, s[28:31], s69 offen offset:0 sc1
    v_mfma_f32_32x32x16_bf16 v[176:191], v[76:79], a[224:227], v[176:191]
    ds_write_b128 v228, v[152:155] offset:6528
    s_waitcnt vmcnt(10)
    v_mfma_f32_32x32x16_bf16 v[160:175], v[80:83], a[228:231], v[160:175]
    buffer_load_dwordx4 a[20:23], v12, s[28:31], s69 offen offset:1024 sc1
    v_mfma_f32_32x32x16_bf16 v[176:191], v[84:87], a[228:231], v[176:191]
    s_add_u32 s69, s44, s39
    ds_write_b128 v228, v[156:159] offset:7616
    s_waitcnt vmcnt(10)
    v_mfma_f32_32x32x16_bf16 v[160:175], v[88:91], a[232:235], v[160:175]
    buffer_load_dwordx4 a[24:27], v12, s[28:31], s69 offen offset:0 sc1
    v_mfma_f32_32x32x16_bf16 v[176:191], v[92:95], a[232:235], v[176:191]
    buffer_load_dwordx4 a[28:31], v12, s[28:31], s69 offen offset:1024 sc1
    s_waitcnt vmcnt(11)
    v_mfma_f32_32x32x16_bf16 v[160:175], v[96:99], a[236:239], v[160:175]
    s_add_u32 s69, s44, s40
    v_mfma_f32_32x32x16_bf16 v[176:191], v[100:103], a[236:239], v[176:191]
    s_waitcnt vmcnt(10)
    v_mfma_f32_32x32x16_bf16 v[160:175], v[104:107], a[240:243], v[160:175]
    buffer_load_dwordx4 a[32:35], v12, s[28:31], s69 offen offset:0 sc1
    v_mfma_f32_32x32x16_bf16 v[176:191], v[108:111], a[240:243], v[176:191]
    buffer_load_dwordx4 a[36:39], v12, s[28:31], s69 offen offset:1024 sc1
    s_waitcnt vmcnt(11)
    v_mfma_f32_32x32x16_bf16 v[160:175], v[112:115], a[244:247], v[160:175]
    s_add_u32 s69, s44, s41
    s_waitcnt lgkmcnt(0)
    s_barrier
    ds_read_b128 v[192:195], v229 offset:0
    ds_read_b128 v[196:199], v229 offset:512
    v_mfma_f32_32x32x16_bf16 v[176:191], v[116:119], a[244:247], v[176:191]
    buffer_load_dwordx4 a[40:43], v12, s[28:31], s69 offen offset:0 sc1
    ds_read_b128 v[200:203], v229 offset:8704
    ds_read_b128 v[204:207], v229 offset:9216
    ds_read_b128 v[208:211], v229 offset:17408
    s_waitcnt vmcnt(11)
    v_mfma_f32_32x32x16_bf16 v[160:175], v[120:123], a[252:255], v[160:175]
    buffer_load_dwordx4 a[44:47], v12, s[28:31], s69 offen offset:1024 sc1
    ds_read_b128 v[212:215], v229 offset:17920
    ds_read_b128 v[216:219], v229 offset:26112
    ds_read_b128 v[220:223], v229 offset:26624
    v_mfma_f32_32x32x16_bf16 v[176:191], v[124:127], a[252:255], v[176:191]
    s_waitcnt vmcnt(11)
    v_mfma_f32_32x32x16_bf16 v[160:175], a[112:115], a[0:3], v[160:175]
    s_add_u32 s69, s44, s42
    v_mfma_f32_32x32x16_bf16 v[176:191], a[116:119], a[0:3], v[176:191]
    buffer_load_dwordx4 a[48:51], v12, s[28:31], s69 offen offset:0 sc1
    s_waitcnt vmcnt(11)
    v_mfma_f32_32x32x16_bf16 v[160:175], a[120:123], a[4:7], v[160:175]
    buffer_load_dwordx4 a[52:55], v12, s[28:31], s69 offen offset:1024 sc1
    v_mfma_f32_32x32x16_bf16 v[176:191], a[124:127], a[4:7], v[176:191]
    s_add_u32 s44, s44, 229376
    s_waitcnt vmcnt(11)
    v_mfma_f32_32x32x16_bf16 v[160:175], a[128:131], a[8:11], v[160:175]
    s_waitcnt lgkmcnt(5)
    v_add_f32 v192, v192, v200
    s_waitcnt lgkmcnt(1)
    v_add_f32_e64 v208, v208, v216
    v_add_f32 v193, v193, v201
    s_waitcnt vmcnt(10)
    v_mfma_f32_32x32x16_bf16 v[160:175], a[136:139], a[12:15], v[160:175]
    v_add_f32 v209, v209, v217
    v_add_f32 v194, v194, v202
    v_add_f32_e64 v210, v210, v218
    v_add_f32 v195, v195, v203
    s_waitcnt vmcnt(9)
    v_mfma_f32_32x32x16_bf16 v[160:175], a[144:147], a[16:19], v[160:175]
    s_lshl_b32 s62, s3, 6
    s_sub_u32 s63, s79, s62
    v_and_b32_e64 v239, 3, v1
    v_lshl_add_u32 v238, v239, 6, s63
    v_add_f32 v211, v211, v219
    s_waitcnt vmcnt(8)
    v_mfma_f32_32x32x16_bf16 v[160:175], a[152:155], a[20:23], v[160:175]
    v_add_f32 v196, v196, v204
    s_waitcnt lgkmcnt(0)
    v_add_f32 v212, v212, v220
    v_add_f32 v197, v197, v205
    s_waitcnt vmcnt(7)
    v_mfma_f32_32x32x16_bf16 v[160:175], a[160:163], a[24:27], v[160:175]
    s_mov_b64 exec, 0xffff00
    s_lshl_b32 s62, s4, 10
    s_and_b32 s63, s5, 1
    s_lshl_b32 s63, s63, 5
    s_add_u32 s62, s62, s63
    s_lshr_b32 s63, s5, 1
    s_lshl_b32 s63, s63, 2
    s_add_u32 s62, s62, s63
    s_add_u32 s62, s62, 11776
    v_lshl_add_u32 v238, v1, 6, s62
    s_mov_b64 exec, -1
    s_waitcnt vmcnt(6)
    v_mfma_f32_32x32x16_bf16 v[160:175], a[168:171], a[28:31], v[160:175]
    v_add_f32 v213, v213, v221
    v_add_f32 v198, v198, v206
    v_add_f32_e64 v214, v214, v222
    v_add_f32 v199, v199, v207
    s_waitcnt vmcnt(5)
    v_mfma_f32_32x32x16_bf16 v[160:175], a[176:179], a[32:35], v[160:175]
    s_mov_b64 exec, 0xf0
    s_lshl_b32 s62, s7, 6
    s_lshl_b32 s63, s6, 3
    s_add_u32 s62, s62, s63
    s_add_u32 s62, s62, s76
    v_and_b32_e64 v239, 1, v1
    v_lshl_add_u32 v238, v239, 2, s62
    v_and_b32_e64 v239, 2, v1
    v_lshl_add_u32 v238, v239, 6, v238
    s_mov_b64 exec, -1
    s_waitcnt vmcnt(4)
    v_mfma_f32_32x32x16_bf16 v[160:175], a[184:187], a[36:39], v[160:175]
    v_add_f32 v215, v215, v223
    v_add_f32 v192, v192, v208
    v_add_f32_e64 v193, v193, v209
    v_add_f32 v194, v194, v210
    s_waitcnt vmcnt(3)
    v_mfma_f32_32x32x16_bf16 v[160:175], a[192:195], a[40:43], v[160:175]
    v_add_f32 v195, v195, v211
    s_cmp_eq_u32 s3, 0
    s_cselect_b32 s62, 0, 0x7ff00000
    s_add_u32 s62, s62, 65536
    buffer_store_dword v14, v238, s[28:31], s62 offen sc1
    s_waitcnt vmcnt(3)
    v_mfma_f32_32x32x16_bf16 v[160:175], a[200:203], a[44:47], v[160:175]
    v_add_f32 v196, v196, v212
    v_add_f32 v197, v197, v213
    v_add_f32 v198, v198, v214
    v_add_f32_e64 v199, v199, v215
    s_waitcnt vmcnt(2)
    v_mfma_f32_32x32x16_bf16 v[160:175], a[208:211], a[48:51], v[160:175]
    v_fma_f32 v192, v192, v232, v240
    s_or_b32 s62, s2, s3
    s_cselect_b32 s62, 0x7ffffff0, 0
    buffer_store_dword v14, v15, s[28:31], s62 offen sc1
    v_fma_f32 v193, v193, v232, v241
    s_waitcnt vmcnt(2)
    v_mfma_f32_32x32x16_bf16 v[160:175], a[216:219], a[52:55], v[160:175]
    v_fma_f32 v194, v194, v232, v242
    v_fma_f32 v195, v195, v232, v243
    v_fma_f32 v196, v196, v232, v244
    v_fma_f32 v197, v197, v232, v245
    v_mfma_f32_32x32x16_bf16 v[176:191], a[132:135], a[8:11], v[176:191]
    v_fma_f32 v198, v198, v232, v246
    v_fma_f32 v199, v199, v232, v247
    v_cvt_pk_bf16_f32 v224, v192, v193
    v_cvt_pk_bf16_f32 v225, v194, v195
    v_cvt_pk_bf16_f32 v226, v196, v197
    v_mfma_f32_32x32x16_bf16 v[176:191], a[140:143], a[12:15], v[176:191]
    v_cvt_pk_bf16_f32 v227, v198, v199
    buffer_store_dwordx4 v[224:227], v230, s[32:35], s48 offen sc1
    s_add_u32 s48, s48, 57344
    v_mfma_f32_32x32x16_bf16 v[176:191], a[148:151], a[16:19], v[176:191]
    ds_write_b128 v228, v[160:163] offset:36864
    v_mfma_f32_32x32x16_bf16 v[176:191], a[156:159], a[20:23], v[176:191]
    v_mfma_f32_32x32x16_bf16 v[176:191], a[164:167], a[24:27], v[176:191]
    ds_write_b128 v228, v[164:167] offset:37952
    v_mfma_f32_32x32x16_bf16 v[176:191], a[172:175], a[28:31], v[176:191]
    v_mfma_f32_32x32x16_bf16 v[176:191], a[180:183], a[32:35], v[176:191]
    v_mfma_f32_32x32x16_bf16 v[176:191], a[188:191], a[36:39], v[176:191]
    ds_write_b128 v228, v[168:171] offset:39040
    v_mfma_f32_32x32x16_bf16 v[176:191], a[196:199], a[40:43], v[176:191]
    v_mfma_f32_32x32x16_bf16 v[176:191], a[204:207], a[44:47], v[176:191]
    ds_write_b128 v228, v[172:175] offset:40128
    v_mfma_f32_32x32x16_bf16 v[176:191], a[212:215], a[48:51], v[176:191]
    v_mfma_f32_32x32x16_bf16 v[176:191], a[220:223], a[52:55], v[176:191]
    s_nop 11
    ds_write_b128 v228, v[176:179] offset:41216
    ds_write_b128 v228, v[180:183] offset:42304
    ds_write_b128 v228, v[184:187] offset:43392
    ds_write_b128 v228, v[188:191] offset:44480
    s_waitcnt lgkmcnt(0)
    s_barrier
    ds_read_b128 v[192:195], v229 offset:36864
    ds_read_b128 v[196:199], v229 offset:37376
    ds_read_b128 v[200:203], v229 offset:45568
    ds_read_b128 v[204:207], v229 offset:46080
    ds_read_b128 v[208:211], v229 offset:54272
    ds_read_b128 v[212:215], v229 offset:54784
    ds_read_b128 v[216:219], v229 offset:62976
    ds_read_b128 v[220:223], v229 offset:63488
    s_waitcnt lgkmcnt(5)
    v_pk_add_f32 v[192:193], v[192:193], v[200:201]
    v_pk_add_f32 v[194:195], v[194:195], v[202:203]
    s_waitcnt lgkmcnt(4)
    v_pk_add_f32 v[196:197], v[196:197], v[204:205]
    v_pk_add_f32 v[198:199], v[198:199], v[206:207]
    s_waitcnt lgkmcnt(1)
    v_pk_add_f32 v[208:209], v[208:209], v[216:217]
    v_pk_add_f32 v[210:211], v[210:211], v[218:219]
    s_waitcnt lgkmcnt(0)
    v_pk_add_f32 v[212:213], v[212:213], v[220:221]
    v_pk_add_f32 v[214:215], v[214:215], v[222:223]
    v_pk_add_f32 v[192:193], v[192:193], v[208:209]
    v_pk_add_f32 v[194:195], v[194:195], v[210:211]
    v_pk_add_f32 v[196:197], v[196:197], v[212:213]
    v_pk_add_f32 v[198:199], v[198:199], v[214:215]
    v_pk_fma_f32 v[192:193], v[192:193], v[234:235], v[240:241] op_sel:[0,0,0] op_sel_hi:[1,0,1]
    v_pk_fma_f32 v[194:195], v[194:195], v[234:235], v[242:243] op_sel:[0,0,0] op_sel_hi:[1,0,1]
    v_pk_fma_f32 v[196:197], v[196:197], v[234:235], v[244:245] op_sel:[0,0,0] op_sel_hi:[1,0,1]
    v_pk_fma_f32 v[198:199], v[198:199], v[234:235], v[246:247] op_sel:[0,0,0] op_sel_hi:[1,0,1]
    v_cvt_pk_bf16_f32 v224, v192, v193
    v_cvt_pk_bf16_f32 v225, v194, v195
    v_cvt_pk_bf16_f32 v226, v196, v197
    v_cvt_pk_bf16_f32 v227, v198, v199
    buffer_store_dwordx4 v[224:227], v230, s[32:35], s48 offen sc1
    s_add_u32 s48, s48, 57344
    s_endpgm
Lh1r:
    s_nop 7
    s_add_u32 s64, s64, 1
    s_cmp_ge_u32 s64, 100000
    s_cbranch_scc1 Lh1d
    s_add_u32 s62, s4, 0
    s_and_b32 s62, s62, 14
    s_lshl_b32 s62, s62, 11
    s_add_u32 s62, s62, s81
    buffer_load_dwordx4 v[16:19], v7, s[28:31], s62 offen sc1
    s_add_u32 s62, s4, 2
    s_and_b32 s62, s62, 14
    s_lshl_b32 s62, s62, 11
    s_add_u32 s62, s62, s81
    buffer_load_dwordx4 v[32:35], v7, s[28:31], s62 offen sc1
    s_add_u32 s62, s4, 4
    s_and_b32 s62, s62, 14
    s_lshl_b32 s62, s62, 11
    s_add_u32 s62, s62, s81
    buffer_load_dwordx4 v[48:51], v7, s[28:31], s62 offen sc1
    s_add_u32 s62, s4, 6
    s_and_b32 s62, s62, 14
    s_lshl_b32 s62, s62, 11
    s_add_u32 s62, s62, s81
    buffer_load_dwordx4 v[64:67], v7, s[28:31], s62 offen sc1
    s_add_u32 s62, s4, 8
    s_and_b32 s62, s62, 14
    s_lshl_b32 s62, s62, 11
    s_add_u32 s62, s62, s81
    buffer_load_dwordx4 v[80:83], v7, s[28:31], s62 offen sc1
    s_add_u32 s62, s4, 10
    s_and_b32 s62, s62, 14
    s_lshl_b32 s62, s62, 11
    s_add_u32 s62, s62, s81
    buffer_load_dwordx4 v[96:99], v7, s[28:31], s62 offen sc1
    s_add_u32 s62, s4, 12
    s_and_b32 s62, s62, 14
    s_lshl_b32 s62, s62, 11
    s_add_u32 s62, s62, s81
    buffer_load_dwordx4 v[112:115], v7, s[28:31], s62 offen sc1
    s_add_u32 s62, s4, 14
    s_and_b32 s62, s62, 14
    s_lshl_b32 s62, s62, 11
    s_add_u32 s62, s62, s81
    buffer_load_dwordx4 v[20:23], v7, s[28:31], s62 offen sc1
    s_branch Lh1
    s_branch Lh1d
Lsl_2:
    s_nop 2
    s_mov_b32 s64, 0
Lpoll_3:
    buffer_load_dword v13, v7, s[28:31], s70 offen sc1
    s_waitcnt vmcnt(0)
    v_cmp_ne_u32 vcc, v13, v14
    s_nop 0
    s_cbranch_vccz Lpd_1
    s_add_u32 s64, s64, 1
    s_and_b32 s62, s64, 15
    s_cbranch_scc1 Lpoll_3
    s_lshl_b32 s62, s3, 6
    s_sub_u32 s63, s79, s62
    v_and_b32 v239, 3, v1
    v_lshl_add_u32 v238, v239, 6, s63
    s_mov_b64 exec, 0xffff00
    s_lshl_b32 s62, s4, 10
    s_and_b32 s63, s5, 1
    s_lshl_b32 s63, s63, 5
    s_add_u32 s62, s62, s63
    s_lshr_b32 s63, s5, 1
    s_lshl_b32 s63, s63, 2
    s_add_u32 s62, s62, s63
    s_add_u32 s62, s62, 11776
    v_lshl_add_u32 v238, v1, 6, s62
    s_mov_b64 exec, -1
    s_mov_b64 exec, 0xf0
    s_lshl_b32 s62, s7, 6
    s_lshl_b32 s63, s6, 3
    s_add_u32 s62, s62, s63
    s_add_u32 s62, s62, s76
    v_and_b32_e64 v239, 1, v1
    v_lshl_add_u32 v238, v239, 2, s62
    v_and_b32 v239, 2, v1
    v_lshl_add_u32 v238, v239, 6, v238
    s_mov_b64 exec, -1
    s_mov_b32 s63, 65536
    buffer_load_dword v13, v238, s[28:31], 0 offen sc1
    s_waitcnt vmcnt(0)
    v_cmp_eq_u32 vcc, v13, v14
    v_mov_b32 v13, 0x7ffffff0
    s_nop 0
    v_cndmask_b32 v13, v13, v238, vcc
    buffer_store_dword v14, v13, s[28:31], s63 offen sc1
    s_add_u32 s63, s70, 65536
    buffer_load_dword v13, v7, s[28:31], s63 offen sc1
    s_waitcnt vmcnt(0)
    v_cmp_ne_u32 vcc, v13, v14
    s_nop 0
    s_cbranch_vccz Lpd_1
    s_cmp_lt_u32 s64, 400000
    s_cbranch_scc1 Lpoll_3
    s_branch Lpd_1
Lsl_5:
    s_nop 2
    s_mov_b32 s64, 0
Lpoll_6:
    buffer_load_dword v235, v7, s[28:31], s76 offen sc1
    s_waitcnt vmcnt(0)
    v_cmp_ne_u32 vcc, v235, v14
    s_nop 0
    s_cbranch_vccz Lpd_4
    s_add_u32 s64, s64, 1
    s_and_b32 s62, s64, 15
    s_cbranch_scc1 Lpoll_6
    s_lshl_b32 s62, s3, 6
    s_sub_u32 s63, s79, s62
    v_and_b32 v239, 3, v1
    v_lshl_add_u32 v238, v239, 6, s63
    s_mov_b64 exec, 0xffff00
    s_lshl_b32 s62, s4, 10
    s_and_b32 s63, s5, 1
    s_lshl_b32 s63, s63, 5
    s_add_u32 s62, s62, s63
    s_lshr_b32 s63, s5, 1
    s_lshl_b32 s63, s63, 2
    s_add_u32 s62, s62, s63
    s_add_u32 s62, s62, 11776
    v_lshl_add_u32 v238, v1, 6, s62
    s_mov_b64 exec, -1
    s_mov_b64 exec, 0xf0
    s_lshl_b32 s62, s7, 6
    s_lshl_b32 s63, s6, 3
    s_add_u32 s62, s62, s63
    s_add_u32 s62, s62, s76
    v_and_b32_e64 v239, 1, v1
    v_lshl_add_u32 v238, v239, 2, s62
    v_and_b32 v239, 2, v1
    v_lshl_add_u32 v238, v239, 6, v238
    s_mov_b64 exec, -1
    s_mov_b32 s63, 65536
    buffer_load_dword v235, v238, s[28:31], 0 offen sc1
    s_waitcnt vmcnt(0)
    v_cmp_eq_u32 vcc, v235, v14
    v_mov_b32 v235, 0x7ffffff0
    s_nop 0
    v_cndmask_b32 v235, v235, v238, vcc
    buffer_store_dword v14, v235, s[28:31], s63 offen sc1
    s_add_u32 s63, s76, 65536
    buffer_load_dword v235, v7, s[28:31], s63 offen sc1
    s_waitcnt vmcnt(0)
    v_cmp_ne_u32 vcc, v235, v14
    s_nop 0
    s_cbranch_vccz Lpd_4
    s_cmp_lt_u32 s64, 400000
    s_cbranch_scc1 Lpoll_6
    s_branch Lpd_4
Lsl_8:
    s_nop 7
    s_mov_b32 s64, 0
Lpoll_9:
    buffer_load_dword v13, v7, s[28:31], s67 offen sc1
    s_waitcnt vmcnt(0)
    v_cmp_ne_u32 vcc, v13, v14
    s_nop 0
    s_cbranch_vccz Lpd_7
    s_add_u32 s64, s64, 1
    s_and_b32 s62, s64, 15
    s_cbranch_scc1 Lpoll_9
    s_lshl_b32 s62, s3, 6
    s_sub_u32 s63, s79, s62
    v_and_b32 v239, 3, v1
    v_lshl_add_u32 v238, v239, 6, s63
    s_mov_b64 exec, 0xffff00
    s_lshl_b32 s62, s4, 10
    s_and_b32 s63, s5, 1
    s_lshl_b32 s63, s63, 5
    s_add_u32 s62, s62, s63
    s_lshr_b32 s63, s5, 1
    s_lshl_b32 s63, s63, 2
    s_add_u32 s62, s62, s63
    s_add_u32 s62, s62, 11776
    v_lshl_add_u32 v238, v1, 6, s62
    s_mov_b64 exec, -1
    s_mov_b64 exec, 0xf0
    s_lshl_b32 s62, s7, 6
    s_lshl_b32 s63, s6, 3
    s_add_u32 s62, s62, s63
    s_add_u32 s62, s62, s76
    v_and_b32_e64 v239, 1, v1
    v_lshl_add_u32 v238, v239, 2, s62
    v_and_b32 v239, 2, v1
    v_lshl_add_u32 v238, v239, 6, v238
    s_mov_b64 exec, -1
    s_mov_b32 s63, 65536
    buffer_load_dword v13, v238, s[28:31], 0 offen sc1
    s_waitcnt vmcnt(0)
    v_cmp_eq_u32 vcc, v13, v14
    v_mov_b32 v13, 0x7ffffff0
    s_nop 0
    v_cndmask_b32 v13, v13, v238, vcc
    buffer_store_dword v14, v13, s[28:31], s63 offen sc1
    s_add_u32 s63, s67, 65536
    buffer_load_dword v13, v7, s[28:31], s63 offen sc1
    s_waitcnt vmcnt(0)
    v_cmp_ne_u32 vcc, v13, v14
    s_nop 0
    s_cbranch_vccz Lpd_7
    s_cmp_lt_u32 s64, 400000
    s_cbranch_scc1 Lpoll_9
    s_branch Lpd_7
Lsl_15:
    s_nop 7
    s_mov_b32 s64, 0
Lpoll_16:
    buffer_load_dword v13, v7, s[28:31], s45 offen sc1
    s_waitcnt vmcnt(0)
    v_cmp_ne_u32 vcc, v13, v14
    s_nop 0
    s_cbranch_vccz Lpd_14
    s_add_u32 s64, s64, 1
    s_and_b32 s62, s64, 15
    s_cbranch_scc1 Lpoll_16
    s_lshl_b32 s62, s3, 6
    s_sub_u32 s63, s79, s62
    v_and_b32 v239, 3, v1
    v_lshl_add_u32 v238, v239, 6, s63
    s_mov_b64 exec, 0xffff00
    s_lshl_b32 s62, s4, 10
    s_and_b32 s63, s5, 1
    s_lshl_b32 s63, s63, 5
    s_add_u32 s62, s62, s63
    s_lshr_b32 s63, s5, 1
    s_lshl_b32 s63, s63, 2
    s_add_u32 s62, s62, s63
    s_add_u32 s62, s62, 11776
    v_lshl_add_u32 v238, v1, 6, s62
    s_mov_b64 exec, -1
    s_mov_b64 exec, 0xf0
    s_lshl_b32 s62, s7, 6
    s_lshl_b32 s63, s6, 3
    s_add_u32 s62, s62, s63
    s_add_u32 s62, s62, s76
    v_and_b32_e64 v239, 1, v1
    v_lshl_add_u32 v238, v239, 2, s62
    v_and_b32 v239, 2, v1
    v_lshl_add_u32 v238, v239, 6, v238
    s_mov_b64 exec, -1
    s_mov_b32 s63, 65536
    buffer_load_dword v13, v238, s[28:31], 0 offen sc1
    s_waitcnt vmcnt(0)
    v_cmp_eq_u32 vcc, v13, v14
    v_mov_b32 v13, 0x7ffffff0
    s_nop 0
    v_cndmask_b32 v13, v13, v238, vcc
    buffer_store_dword v14, v13, s[28:31], s63 offen sc1
    s_add_u32 s63, s45, 65536
    buffer_load_dword v13, v7, s[28:31], s63 offen sc1
    s_waitcnt vmcnt(0)
    v_cmp_ne_u32 vcc, v13, v14
    s_nop 0
    s_cbranch_vccz Lpd_14
    s_cmp_lt_u32 s64, 400000
    s_cbranch_scc1 Lpoll_16
    s_branch Lpd_14
Lsl_18:
    s_nop 7
    s_mov_b32 s64, 0
Lpoll_19:
    buffer_load_dword v13, v7, s[28:31], s67 offen sc1
    s_waitcnt vmcnt(0)
    v_cmp_ne_u32 vcc, v13, v14
    s_nop 0
    s_cbranch_vccz Lpd_17
    s_add_u32 s64, s64, 1
    s_and_b32 s62, s64, 15
    s_cbranch_scc1 Lpoll_19
    s_lshl_b32 s62, s3, 6
    s_sub_u32 s63, s79, s62
    v_and_b32 v239, 3, v1
    v_lshl_add_u32 v238, v239, 6, s63
    s_mov_b64 exec, 0xffff00
    s_lshl_b32 s62, s4, 10
    s_and_b32 s63, s5, 1
    s_lshl_b32 s63, s63, 5
    s_add_u32 s62, s62, s63
    s_lshr_b32 s63, s5, 1
    s_lshl_b32 s63, s63, 2
    s_add_u32 s62, s62, s63
    s_add_u32 s62, s62, 11776
    v_lshl_add_u32 v238, v1, 6, s62
    s_mov_b64 exec, -1
    s_mov_b64 exec, 0xf0
    s_lshl_b32 s62, s7, 6
    s_lshl_b32 s63, s6, 3
    s_add_u32 s62, s62, s63
    s_add_u32 s62, s62, s76
    v_and_b32_e64 v239, 1, v1
    v_lshl_add_u32 v238, v239, 2, s62
    v_and_b32 v239, 2, v1
    v_lshl_add_u32 v238, v239, 6, v238
    s_mov_b64 exec, -1
    s_mov_b32 s63, 65536
    buffer_load_dword v13, v238, s[28:31], 0 offen sc1
    s_waitcnt vmcnt(0)
    v_cmp_eq_u32 vcc, v13, v14
    v_mov_b32 v13, 0x7ffffff0
    s_nop 0
    v_cndmask_b32 v13, v13, v238, vcc
    buffer_store_dword v14, v13, s[28:31], s63 offen sc1
    s_add_u32 s63, s67, 65536
    buffer_load_dword v13, v7, s[28:31], s63 offen sc1
    s_waitcnt vmcnt(0)
    v_cmp_ne_u32 vcc, v13, v14
    s_nop 0
    s_cbranch_vccz Lpd_17
    s_cmp_lt_u32 s64, 400000
    s_cbranch_scc1 Lpoll_19
    s_branch Lpd_17
Lsl_25:
    s_nop 7
    s_mov_b32 s64, 0
Lpoll_26:
    buffer_load_dword v13, v7, s[28:31], s45 offen sc1
    s_waitcnt vmcnt(0)
    v_cmp_ne_u32 vcc, v13, v14
    s_nop 0
    s_cbranch_vccz Lpd_24
    s_add_u32 s64, s64, 1
    s_and_b32 s62, s64, 15
    s_cbranch_scc1 Lpoll_26
    s_lshl_b32 s62, s3, 6
    s_sub_u32 s63, s79, s62
    v_and_b32 v239, 3, v1
    v_lshl_add_u32 v238, v239, 6, s63
    s_mov_b64 exec, 0xffff00
    s_lshl_b32 s62, s4, 10
    s_and_b32 s63, s5, 1
    s_lshl_b32 s63, s63, 5
    s_add_u32 s62, s62, s63
    s_lshr_b32 s63, s5, 1
    s_lshl_b32 s63, s63, 2
    s_add_u32 s62, s62, s63
    s_add_u32 s62, s62, 11776
    v_lshl_add_u32 v238, v1, 6, s62
    s_mov_b64 exec, -1
    s_mov_b64 exec, 0xf0
    s_lshl_b32 s62, s7, 6
    s_lshl_b32 s63, s6, 3
    s_add_u32 s62, s62, s63
    s_add_u32 s62, s62, s76
    v_and_b32_e64 v239, 1, v1
    v_lshl_add_u32 v238, v239, 2, s62
    v_and_b32 v239, 2, v1
    v_lshl_add_u32 v238, v239, 6, v238
    s_mov_b64 exec, -1
    s_mov_b32 s63, 65536
    buffer_load_dword v13, v238, s[28:31], 0 offen sc1
    s_waitcnt vmcnt(0)
    v_cmp_eq_u32 vcc, v13, v14
    v_mov_b32 v13, 0x7ffffff0
    s_nop 0
    v_cndmask_b32 v13, v13, v238, vcc
    buffer_store_dword v14, v13, s[28:31], s63 offen sc1
    s_add_u32 s63, s45, 65536
    buffer_load_dword v13, v7, s[28:31], s63 offen sc1
    s_waitcnt vmcnt(0)
    v_cmp_ne_u32 vcc, v13, v14
    s_nop 0
    s_cbranch_vccz Lpd_24
    s_cmp_lt_u32 s64, 400000
    s_cbranch_scc1 Lpoll_26
    s_branch Lpd_24
Lhelp:
    s_waitcnt vmcnt(0)
    s_mov_b64 exec, 1
    buffer_store_dword v14, v15, s[28:31], s79 offen
    s_mov_b64 exec, -1
    s_add_u32 s69, s79, 65536
    s_waitcnt vmcnt(0)
    s_barrier
    s_and_b32 s62, s4, 1
    s_lshl_b32 s62, s62, 1
    s_and_b32 s63, s5, 1
    s_add_u32 s62, s62, s63
    s_lshl_b32 s62, s62, 2
    s_add_u32 s62, s62, s3
    s_lshl_b32 s62, s62, 13
    v_lshlrev_b32_e64 v2, 7, v1
    s_and_b32 s64, s2, 7
    s_mul_i32 s64, s64, 3
    s_lshr_b32 s64, s64, 1
    s_mul_i32 s64, s64, 131072
    s_add_u32 s62, s62, s64
    buffer_load_dword v16, v2, s[24:27], s62 offen
    s_add_u32 s62, s62, 131072
    s_cmp_ge_u32 s62, 1703936
    s_cselect_b32 s64, 1703936, 0
    s_sub_u32 s62, s62, s64
    buffer_load_dword v17, v2, s[24:27], s62 offen
    s_add_u32 s62, s62, 131072
    s_cmp_ge_u32 s62, 1703936
    s_cselect_b32 s64, 1703936, 0
    s_sub_u32 s62, s62, s64
    buffer_load_dword v18, v2, s[24:27], s62 offen
    s_add_u32 s62, s62, 131072
    s_cmp_ge_u32 s62, 1703936
    s_cselect_b32 s64, 1703936, 0
    s_sub_u32 s62, s62, s64
    buffer_load_dword v19, v2, s[24:27], s62 offen
    s_add_u32 s62, s62, 131072
    s_cmp_ge_u32 s62, 1703936
    s_cselect_b32 s64, 1703936, 0
    s_sub_u32 s62, s62, s64
    buffer_load_dword v20, v2, s[24:27], s62 offen
    s_add_u32 s62, s62, 131072
    s_cmp_ge_u32 s62, 1703936
    s_cselect_b32 s64, 1703936, 0
    s_sub_u32 s62, s62, s64
    buffer_load_dword v21, v2, s[24:27], s62 offen
    s_add_u32 s62, s62, 131072
    s_cmp_ge_u32 s62, 1703936
    s_cselect_b32 s64, 1703936, 0
    s_sub_u32 s62, s62, s64
    buffer_load_dword v22, v2, s[24:27], s62 offen
    s_add_u32 s62, s62, 131072
    s_cmp_ge_u32 s62, 1703936
    s_cselect_b32 s64, 1703936, 0
    s_sub_u32 s62, s62, s64
    buffer_load_dword v23, v2, s[24:27], s62 offen
    s_add_u32 s62, s62, 131072
    s_cmp_ge_u32 s62, 1703936
    s_cselect_b32 s64, 1703936, 0
    s_sub_u32 s62, s62, s64
    buffer_load_dword v24, v2, s[24:27], s62 offen
    s_add_u32 s62, s62, 131072
    s_cmp_ge_u32 s62, 1703936
    s_cselect_b32 s64, 1703936, 0
    s_sub_u32 s62, s62, s64
    buffer_load_dword v25, v2, s[24:27], s62 offen
    s_add_u32 s62, s62, 131072
    s_cmp_ge_u32 s62, 1703936
    s_cselect_b32 s64, 1703936, 0
    s_sub_u32 s62, s62, s64
    buffer_load_dword v26, v2, s[24:27], s62 offen
    s_add_u32 s62, s62, 131072
    s_cmp_ge_u32 s62, 1703936
    s_cselect_b32 s64, 1703936, 0
    s_sub_u32 s62, s62, s64
    buffer_load_dword v27, v2, s[24:27], s62 offen
    s_add_u32 s62, s62, 131072
    s_cmp_ge_u32 s62, 1703936
    s_cselect_b32 s64, 1703936, 0
    s_sub_u32 s62, s62, s64
    buffer_load_dword v28, v2, s[24:27], s62 offen
    s_add_u32 s62, s62, 131072
    s_cmp_ge_u32 s62, 1703936
    s_cselect_b32 s64, 1703936, 0
    s_sub_u32 s62, s62, s64
    s_waitcnt vmcnt(0)
    buffer_store_dword v14, v15, s[28:31], s69 offen sc1
Lfin:
Lend:
    s_endpgm
.section .rodata,"a"
.p2align 6
.amdhsa_kernel sequential_preLN__linear_attn_block__dense_activation_squared_relu__prompt_kernel
  .amdhsa_next_free_vgpr 512
  .amdhsa_next_free_sgpr 102
  .amdhsa_accum_offset 256
  .amdhsa_group_segment_fixed_size 0
  .amdhsa_kernarg_size 88
  .amdhsa_user_sgpr_count 2
  .amdhsa_user_sgpr_kernarg_segment_ptr 1
  .amdhsa_system_sgpr_workgroup_id_x 1
.end_amdhsa_kernel
```
